```python
import torch

def _softmax(x, axis=-1):
    return torch.softmax(x, dim=axis)

def _gelu(x):
    return torch.nn.functional.gelu(x, approximate='tanh')

def _silu(x):
    return torch.nn.functional.silu(x)

def _sigmoid(x):
    return torch.sigmoid(x)

def _layernorm(x, axis=-1, eps=1e-05):
    m = x.mean(dim=axis, keepdim=True)
    v = x.var(dim=axis, keepdim=True, unbiased=False)
    return (x - m) / torch.sqrt(v + eps)

def _scatter_add(tgt, idx, src, axis=0):
    return tgt.clone().index_add_(axis, idx, src)

def _segment_sum(src, seg, n):
    out = torch.zeros((n,) + src.shape[1:], dtype=src.dtype)
    return out.index_add_(0, seg, src)

def _pad(x, pw):
    flat = tuple((v for pair in reversed(pw) for v in pair))
    return torch.nn.functional.pad(x, flat)
kernel_name = 'adaLN_cond__gqa_block_cached__mixer_token_mlp__decode'

def setup_inputs():

    _w = lambda a: (lambda t: t.to(torch.bfloat16) if t.is_floating_point() else t)(torch.as_tensor(a))

    def _A_setup():
        B, Sq, D = (2, 1, 1024)
        Hq, Hkv, Sk, Dh = (32, 4, 32768, 128)
        assert Hq % Hkv == 0, (Hq, Hkv)
        return {'x': _w((lambda *s: torch.randn(*s, dtype=torch.bfloat16) * 0.05)(B, Sq, D)), 'k_cache': _w((lambda *s: torch.randn(*s, dtype=torch.bfloat16) * 3.2)(B, Hkv, Sk, Dh)), 'v_cache': _w((lambda *s: torch.randn(*s, dtype=torch.bfloat16) * 1.6)(B, Hkv, Sk, Dh)), 'wq': _w((lambda *s: torch.randn(*s, dtype=torch.bfloat16) * 3.2)(D, Hq * Dh) * D ** (-0.5)), 'wo': _w((lambda *s: torch.randn(*s, dtype=torch.bfloat16) * 1.6)(Hq * Dh, D) * (Hq * Dh) ** (-0.5))}
    _A_in = _A_setup()

    def _B_setup():
        B, S, D, F = (2, 1, 1024, 3584)
        return {'x': _w((lambda *s: torch.randn(*s, dtype=torch.bfloat16) * 0.05)(B, S, D)), 'w1': _w((lambda *s: torch.randn(*s, dtype=torch.bfloat16) * 1.6)(S, F) * S ** (-0.5)), 'b1': _w((lambda *s: torch.randn(*s, dtype=torch.bfloat16) * 1.6)(F) * 0.02), 'w2': _w((lambda *s: torch.randn(*s, dtype=torch.bfloat16) * 1.6)(F, S) * F ** (-0.5)), 'b2': _w((lambda *s: torch.randn(*s, dtype=torch.bfloat16) * 1.6)(S) * 0.02)}
    _B_in = _B_setup()
    return {'A_x': _A_in['x'], 'A_k_cache': _A_in['k_cache'], 'A_v_cache': _A_in['v_cache'], 'A_wq': _A_in['wq'], 'A_wo': _A_in['wo'], 'B_x': _B_in['x'], 'B_w1': _B_in['w1'], 'B_b1': _B_in['b1'], 'B_w2': _B_in['w2'], 'B_b2': _B_in['b2'], 'c': _w((lambda *s: torch.randn(*s, dtype=torch.bfloat16) * 0.05)(2, 1024) * 8.0), 'w_mod': _w((lambda *s: torch.randn(*s, dtype=torch.bfloat16) * 0.05)(1024, 6 * 1024) * 1024 ** (-0.5) * 8.0)}

def reference(A_x, A_k_cache, A_v_cache, A_wq, A_wo, B_x, B_w1, B_b1, B_w2, B_b2, c, w_mod):

    def _A_ref(x, k_cache, v_cache, wq, wo):
        B, Sq, D = x.shape
        Hq, Dh = (32, 128)
        Hkv = k_cache.shape[1]
        rep = Hq // Hkv
        q = (lambda x, *d: x.permute(*d))((x @ wq).reshape(B, Sq, Hq, Dh), 0, 2, 1, 3)
        k = (lambda x, n, axis: torch.repeat_interleave(x, n, dim=axis))(k_cache, rep, axis=1)
        v = (lambda x, n, axis: torch.repeat_interleave(x, n, dim=axis))(v_cache, rep, axis=1)
        scores = torch.einsum('bhqd,bhkd->bhqk', q, k) * Dh ** (-0.5)
        p = _softmax(scores, axis=-1)
        o = torch.einsum('bhqk,bhkd->bhqd', p, v)
        return (lambda x, *d: x.permute(*d))(o, 0, 2, 1, 3).reshape(B, Sq, Hq * Dh) @ wo

    def _B_ref(x, w1, b1, w2, b2):
        B, S, D = x.shape
        h = _layernorm(x, axis=-1)
        u = torch.einsum('bsd,sf->bdf', h, w1) + b1
        u = _gelu(u)
        y = torch.einsum('bdf,fs->bds', u, w2) + b2
        return (lambda x, *d: x.permute(*d))(y, 0, 2, 1)
    x = A_x
    mod = (_silu(c) @ w_mod).reshape(c.shape[0], 6, 1, -1)
    sa, ca, ga, sb, cb, gb = (mod[:, 0].clone(), mod[:, 1].clone(), mod[:, 2].clone(), mod[:, 3].clone(), mod[:, 4].clone(), mod[:, 5].clone())
    h = _layernorm(x, axis=-1) * (1 + ca) + sa
    x = x + ga * _A_ref(h, A_k_cache, A_v_cache, A_wq, A_wo)
    h = _layernorm(x, axis=-1) * (1 + cb) + sb
    x = x + gb * _B_ref(h, B_w1, B_b1, B_w2, B_b2)
    return x
```

```asm
; @launch grid=(256,1,1) block=(768,1,1) lds=148480
.amdgcn_target "amdgcn-amd-amdhsa--gfx950"
.text
.globl adaLN_cond__gqa_block_cached__mixer_token_mlp__decode_kernel
.p2align 8
.type adaLN_cond__gqa_block_cached__mixer_token_mlp__decode_kernel,@function
adaLN_cond__gqa_block_cached__mixer_token_mlp__decode_kernel:
    s_cmp_ge_u32 s2, 256
    s_cbranch_scc1 L_end
    s_load_dwordx16 s[16:31], s[0:1], 0
    s_load_dwordx8 s[32:39], s[0:1], 64
    s_load_dwordx2 s[40:41], s[0:1], 96
    s_load_dwordx2 s[42:43], s[0:1], 112
    v_lshrrev_b32 v1, 6, v0
    v_and_b32 v0, 63, v0
    v_readfirstlane_b32 s3, v1
    s_mov_b32 s12, 0x05040100
    s_mov_b32 s13, 0x07060302
    s_cmp_lt_u32 s3, 4
    s_nop 0
    s_cbranch_scc1 L_ctrl
    s_setprio 1
    s_cmp_lg_u32 s3, 4
    s_cbranch_scc1 L_cp0
    s_getpc_b64 s[8:9]
L_pc0:
    s_lshr_b32 s4, s2, 3
    s_lshl_b32 s4, s4, 10
    s_min_u32 s4, s4, L_codeend-L_pc0-1024
    v_lshlrev_b32 v4, 4, v0
    v_add_u32 v4, s4, v4
    global_load_dwordx4 v[32:35], v4, s[8:9]
L_cp0:
    v_bfe_u32 v1, v0, 1, 1
    v_lshlrev_b32 v1, 13, v1
    v_bfe_u32 v4, v0, 2, 2
    v_lshl_add_u32 v1, v4, 8, v1
    v_lshrrev_b32 v4, 4, v0
    v_lshl_add_u32 v1, v4, 5, v1
    v_and_b32 v4, 1, v0
    v_lshl_add_u32 v1, v4, 4, v1
    v_lshlrev_b32 v2, 4, v0
    v_bfe_u32 v39, v0, 1, 3
    v_lshlrev_b32 v39, 8, v39
    v_lshrrev_b32 v4, 4, v0
    v_lshl_add_u32 v39, v4, 5, v39
    v_and_b32 v4, 1, v0
    v_lshl_add_u32 v39, v4, 4, v39
    s_sub_u32 s6, s3, 4
    s_bfe_u32 s4, s3, 0x10002
    s_lshl_b32 s4, s4, 7
    v_xor_b32 v1, s4, v1
    v_xor_b32 v20, 128, v1
    v_xor_b32 v39, s4, v39
    v_xor_b32 v38, 128, v39
    s_bfe_u32 s4, s2, 0x30000
    s_lshl_b32 s4, s4, 23
    s_bfe_u32 s5, s2, 0x50003
    s_lshl_b32 s5, s5, 18
    s_add_u32 s4, s4, s5
    s_bfe_u32 s5, s6, 0x30000
    s_lshl_b32 s5, s5, 10
    s_add_u32 s4, s4, s5
    s_lshr_b32 s61, s2, 3
    s_mul_i32 s61, s61, 0
    s_and_b32 s61, s61, 262143
    s_sub_u32 s5, 67108864, s4
    s_mov_b32 s14, 0xaaaaaaaa
    s_mov_b32 s15, 0xaaaaaaaa
    v_mov_b32 v3, 0xffff
    v_mov_b32 v9, 0xffff0000
    v_cndmask_b32 v3, v3, v9, s[14:15]
    s_waitcnt lgkmcnt(0)
    s_add_u32 s48, s18, s4
    s_addc_u32 s49, s19, 0
    s_mov_b32 s50, s5
    s_mov_b32 s51, 0x20000
    s_add_u32 s52, s20, s4
    s_addc_u32 s53, s21, 0
    s_mov_b32 s54, s5
    s_mov_b32 s55, 0x20000
    s_mov_b32 s7, s61
    buffer_load_dwordx4 v[40:43], v1, s[48:51], s7 offen nt
    buffer_load_dwordx4 v[44:47], v20, s[48:51], s7 offen nt
    s_add_u32 s7, s7, 16384
    s_and_b32 s7, s7, 0x3ffff
    buffer_load_dwordx4 v[48:51], v1, s[48:51], s7 offen nt
    s_barrier
    s_mul_i32 s62, s6, 14336
    s_add_u32 s62, s62, 33792
    s_waitcnt vmcnt(2)
    buffer_load_dwordx4 v[52:55], v20, s[48:51], s7 offen nt
    s_waitcnt vmcnt(2)
    s_add_u32 s7, s7, 16384
    s_and_b32 s7, s7, 0x3ffff
    buffer_load_dwordx4 v[56:59], v1, s[48:51], s7 offen nt
    s_waitcnt vmcnt(2)
    buffer_load_dwordx4 v[60:63], v20, s[48:51], s7 offen nt
    s_waitcnt vmcnt(2)
    s_add_u32 s7, s7, 16384
    s_and_b32 s7, s7, 0x3ffff
    buffer_load_dwordx4 v[64:67], v1, s[48:51], s7 offen nt
    s_waitcnt vmcnt(2)
    buffer_load_dwordx4 v[68:71], v20, s[48:51], s7 offen nt
    s_waitcnt vmcnt(2)
    s_add_u32 s7, s7, 16384
    s_and_b32 s7, s7, 0x3ffff
    buffer_load_dwordx4 v[72:75], v1, s[48:51], s7 offen nt
    s_waitcnt vmcnt(2)
    buffer_load_dwordx4 v[76:79], v20, s[48:51], s7 offen nt
    s_waitcnt vmcnt(2)
    s_add_u32 s7, s7, 16384
    s_and_b32 s7, s7, 0x3ffff
    buffer_load_dwordx4 v[80:83], v1, s[48:51], s7 offen nt
    s_waitcnt vmcnt(2)
    buffer_load_dwordx4 v[84:87], v20, s[48:51], s7 offen nt
    s_waitcnt vmcnt(2)
    s_add_u32 s7, s7, 16384
    s_and_b32 s7, s7, 0x3ffff
    buffer_load_dwordx4 v[88:91], v1, s[48:51], s7 offen nt
    s_waitcnt vmcnt(2)
    buffer_load_dwordx4 v[92:95], v20, s[48:51], s7 offen nt
    s_waitcnt vmcnt(2)
    s_add_u32 s7, s7, 16384
    s_and_b32 s7, s7, 0x3ffff
    buffer_load_dwordx4 v[96:99], v1, s[48:51], s7 offen nt
    s_waitcnt vmcnt(2)
    buffer_load_dwordx4 v[100:103], v20, s[48:51], s7 offen nt
    s_waitcnt vmcnt(2)
    s_add_u32 s7, s7, 16384
    s_and_b32 s7, s7, 0x3ffff
    buffer_load_dwordx4 v[104:107], v1, s[48:51], s7 offen nt
    s_waitcnt vmcnt(2)
    buffer_load_dwordx4 v[108:111], v20, s[48:51], s7 offen nt
    v_mov_b32 v36, 0
    v_mov_b32 v37, 1
    s_waitcnt lgkmcnt(0)
    s_mov_b64 exec, 1
    ds_add_u32 v36, v37 offset:2856
    s_mov_b64 exec, -1
    s_waitcnt vmcnt(2)
    s_add_u32 s7, s7, 16384
    s_and_b32 s7, s7, 0x3ffff
    buffer_load_dwordx4 v[112:115], v1, s[48:51], s7 offen nt
    s_waitcnt vmcnt(2)
    buffer_load_dwordx4 v[116:119], v20, s[48:51], s7 offen nt
    s_waitcnt vmcnt(2)
    s_add_u32 s7, s7, 16384
    s_and_b32 s7, s7, 0x3ffff
    buffer_load_dwordx4 v[120:123], v1, s[48:51], s7 offen nt
    s_waitcnt vmcnt(2)
    buffer_load_dwordx4 v[124:127], v20, s[48:51], s7 offen nt
    s_waitcnt vmcnt(2)
    s_add_u32 s7, s7, 16384
    s_and_b32 s7, s7, 0x3ffff
    buffer_load_dwordx4 v[128:131], v1, s[48:51], s7 offen nt
    s_waitcnt vmcnt(2)
    buffer_load_dwordx4 v[132:135], v20, s[48:51], s7 offen nt
    s_waitcnt vmcnt(2)
    s_add_u32 s7, s7, 16384
    s_and_b32 s7, s7, 0x3ffff
    buffer_load_dwordx4 v[136:139], v1, s[48:51], s7 offen nt
    s_waitcnt vmcnt(2)
    buffer_load_dwordx4 v[140:143], v20, s[48:51], s7 offen nt
    s_waitcnt vmcnt(2)
    s_add_u32 s7, s7, 16384
    s_and_b32 s7, s7, 0x3ffff
    buffer_load_dwordx4 v[144:147], v1, s[48:51], s7 offen nt
    s_waitcnt vmcnt(2)
    buffer_load_dwordx4 v[148:151], v20, s[48:51], s7 offen nt
    s_waitcnt vmcnt(2)
    s_add_u32 s7, s7, 16384
    s_and_b32 s7, s7, 0x3ffff
    buffer_load_dwordx4 v[152:155], v1, s[48:51], s7 offen nt
    s_waitcnt vmcnt(2)
    buffer_load_dwordx4 v[156:159], v20, s[48:51], s7 offen nt
    s_waitcnt vmcnt(2)
    s_add_u32 s7, s7, 16384
    s_and_b32 s7, s7, 0x3ffff
    buffer_load_dwordx4 v[160:163], v1, s[48:51], s7 offen nt
    s_waitcnt vmcnt(2)
    buffer_load_dwordx4 v[164:167], v20, s[48:51], s7 offen nt
    s_waitcnt vmcnt(2)
    s_mov_b32 s7, s61
    s_add_u32 m0, s62, 0
    s_nop 0
    buffer_load_dwordx4 v2, s[52:55], s7 offen nt lds
    s_waitcnt vmcnt(2)
    s_add_u32 s7, s7, 8192
    s_and_b32 s7, s7, 0x3ffff
    s_add_u32 m0, s62, 1024
    s_nop 0
    buffer_load_dwordx4 v2, s[52:55], s7 offen nt lds
    s_waitcnt vmcnt(2)
    s_add_u32 s7, s7, 8192
    s_and_b32 s7, s7, 0x3ffff
    s_add_u32 m0, s62, 2048
    s_nop 0
    buffer_load_dwordx4 v2, s[52:55], s7 offen nt lds
    s_waitcnt vmcnt(2)
    s_add_u32 s7, s7, 8192
    s_and_b32 s7, s7, 0x3ffff
    s_add_u32 m0, s62, 3072
    s_nop 0
    buffer_load_dwordx4 v2, s[52:55], s7 offen nt lds
    s_waitcnt vmcnt(2)
    s_add_u32 s7, s7, 8192
    s_and_b32 s7, s7, 0x3ffff
    s_add_u32 m0, s62, 4096
    s_nop 0
    buffer_load_dwordx4 v2, s[52:55], s7 offen nt lds
    s_waitcnt vmcnt(2)
    s_add_u32 s7, s7, 8192
    s_and_b32 s7, s7, 0x3ffff
    s_add_u32 m0, s62, 5120
    s_nop 0
    buffer_load_dwordx4 v2, s[52:55], s7 offen nt lds
    s_waitcnt vmcnt(2)
    s_add_u32 s7, s7, 8192
    s_and_b32 s7, s7, 0x3ffff
    s_add_u32 m0, s62, 6144
    s_nop 0
    buffer_load_dwordx4 v2, s[52:55], s7 offen nt lds
    s_waitcnt vmcnt(2)
    s_add_u32 s7, s7, 8192
    s_and_b32 s7, s7, 0x3ffff
    s_add_u32 m0, s62, 7168
    s_nop 0
    buffer_load_dwordx4 v2, s[52:55], s7 offen nt lds
    v_mov_b32 v36, 0
    v_mov_b32 v37, 1
    s_waitcnt lgkmcnt(0)
    s_mov_b64 exec, 1
    ds_add_u32 v36, v37 offset:2860
    s_mov_b64 exec, -1
    s_waitcnt vmcnt(2)
    s_add_u32 s7, s7, 8192
    s_and_b32 s7, s7, 0x3ffff
    s_add_u32 m0, s62, 8192
    s_nop 0
    buffer_load_dwordx4 v2, s[52:55], s7 offen nt lds
    s_waitcnt vmcnt(2)
    s_add_u32 s7, s7, 8192
    s_and_b32 s7, s7, 0x3ffff
    s_add_u32 m0, s62, 9216
    s_nop 0
    buffer_load_dwordx4 v2, s[52:55], s7 offen nt lds
    s_waitcnt vmcnt(2)
    s_add_u32 s7, s7, 8192
    s_and_b32 s7, s7, 0x3ffff
    s_add_u32 m0, s62, 10240
    s_nop 0
    buffer_load_dwordx4 v2, s[52:55], s7 offen nt lds
    s_waitcnt vmcnt(2)
    s_add_u32 s7, s7, 8192
    s_and_b32 s7, s7, 0x3ffff
    s_add_u32 m0, s62, 11264
    s_nop 0
    buffer_load_dwordx4 v2, s[52:55], s7 offen nt lds
    s_waitcnt vmcnt(2)
    s_add_u32 s7, s7, 8192
    s_and_b32 s7, s7, 0x3ffff
    s_add_u32 m0, s62, 12288
    s_nop 0
    buffer_load_dwordx4 v2, s[52:55], s7 offen nt lds
    s_waitcnt vmcnt(2)
    s_add_u32 s7, s7, 8192
    s_and_b32 s7, s7, 0x3ffff
    s_add_u32 m0, s62, 13312
    s_nop 0
    buffer_load_dwordx4 v2, s[52:55], s7 offen nt lds
    s_mov_b32 s10, 2621440
    v_mov_b32 v5, 0
Lspin_1:
    ds_read_b32 v4, v5 offset:2820
    s_waitcnt lgkmcnt(0)
    v_readfirstlane_b32 s11, v4
    s_nop 0
    s_cmp_ge_u32 s11, 4
    s_nop 1
    s_cbranch_scc1 Lspe_2
    s_sleep 1
    s_sub_u32 s10, s10, 1
    s_cbranch_scc0 Lspin_1
Lspe_2:
    ds_read_b128 v[4:7], v39 offset:0
    ds_read_b128 v[8:11], v38 offset:0
    s_waitcnt lgkmcnt(0)
    v_mfma_f32_16x16x32_bf16 v[12:15], v[40:43], v[4:7], 0
    v_mfma_f32_16x16x32_bf16 v[12:15], v[44:47], v[8:11], v[12:15]
    v_mfma_f32_16x16x32_bf16 v[16:19], v[48:51], v[4:7], 0
    v_mfma_f32_16x16x32_bf16 v[16:19], v[52:55], v[8:11], v[16:19]
    s_nop 5
    v_cndmask_b32 v36, v14, v13, s[14:15]
    v_cndmask_b32 v20, v12, v15, s[14:15]
    s_nop 1
    v_add_f32_dpp v20, v36, v20 quad_perm:[1,0,3,2] row_mask:0xf bank_mask:0xf
    v_mfma_f32_16x16x32_bf16 v[12:15], v[56:59], v[4:7], 0
    v_mfma_f32_16x16x32_bf16 v[12:15], v[60:63], v[8:11], v[12:15]
    v_cndmask_b32 v36, v18, v17, s[14:15]
    v_cndmask_b32 v21, v16, v19, s[14:15]
    s_nop 1
    v_add_f32_dpp v21, v36, v21 quad_perm:[1,0,3,2] row_mask:0xf bank_mask:0xf
    v_mfma_f32_16x16x32_bf16 v[16:19], v[64:67], v[4:7], 0
    v_mfma_f32_16x16x32_bf16 v[16:19], v[68:71], v[8:11], v[16:19]
    s_nop 0
    v_cndmask_b32 v36, v14, v13, s[14:15]
    v_cndmask_b32 v22, v12, v15, s[14:15]
    s_nop 1
    v_add_f32_dpp v22, v36, v22 quad_perm:[1,0,3,2] row_mask:0xf bank_mask:0xf
    v_mfma_f32_16x16x32_bf16 v[12:15], v[72:75], v[4:7], 0
    v_mfma_f32_16x16x32_bf16 v[12:15], v[76:79], v[8:11], v[12:15]
    v_cndmask_b32 v36, v18, v17, s[14:15]
    v_cndmask_b32 v23, v16, v19, s[14:15]
    s_nop 1
    v_add_f32_dpp v23, v36, v23 quad_perm:[1,0,3,2] row_mask:0xf bank_mask:0xf
    v_mfma_f32_16x16x32_bf16 v[16:19], v[80:83], v[4:7], 0
    v_mfma_f32_16x16x32_bf16 v[16:19], v[84:87], v[8:11], v[16:19]
    s_nop 0
    v_cndmask_b32 v36, v14, v13, s[14:15]
    v_cndmask_b32 v24, v12, v15, s[14:15]
    s_nop 1
    v_add_f32_dpp v24, v36, v24 quad_perm:[1,0,3,2] row_mask:0xf bank_mask:0xf
    v_mfma_f32_16x16x32_bf16 v[12:15], v[88:91], v[4:7], 0
    v_mfma_f32_16x16x32_bf16 v[12:15], v[92:95], v[8:11], v[12:15]
    v_cndmask_b32 v36, v18, v17, s[14:15]
    v_cndmask_b32 v25, v16, v19, s[14:15]
    s_nop 1
    v_add_f32_dpp v25, v36, v25 quad_perm:[1,0,3,2] row_mask:0xf bank_mask:0xf
    v_mfma_f32_16x16x32_bf16 v[16:19], v[96:99], v[4:7], 0
    v_mfma_f32_16x16x32_bf16 v[16:19], v[100:103], v[8:11], v[16:19]
    s_nop 0
    v_cndmask_b32 v36, v14, v13, s[14:15]
    v_cndmask_b32 v26, v12, v15, s[14:15]
    s_nop 1
    v_add_f32_dpp v26, v36, v26 quad_perm:[1,0,3,2] row_mask:0xf bank_mask:0xf
    s_waitcnt vmcnt(2)
    s_add_u32 s7, s7, 8192
    s_and_b32 s7, s7, 0x3ffff
    buffer_load_dwordx4 v[96:99], v2, s[52:55], s7 offen nt
    v_mfma_f32_16x16x32_bf16 v[12:15], v[104:107], v[4:7], 0
    v_mfma_f32_16x16x32_bf16 v[12:15], v[108:111], v[8:11], v[12:15]
    v_cndmask_b32 v36, v18, v17, s[14:15]
    v_cndmask_b32 v27, v16, v19, s[14:15]
    s_nop 1
    v_add_f32_dpp v27, v36, v27 quad_perm:[1,0,3,2] row_mask:0xf bank_mask:0xf
    s_waitcnt vmcnt(2)
    s_add_u32 s7, s7, 8192
    s_and_b32 s7, s7, 0x3ffff
    buffer_load_dwordx4 v[100:103], v2, s[52:55], s7 offen nt
    v_mfma_f32_16x16x32_bf16 v[16:19], v[112:115], v[4:7], 0
    v_mfma_f32_16x16x32_bf16 v[16:19], v[116:119], v[8:11], v[16:19]
    v_cndmask_b32 v36, v14, v13, s[14:15]
    v_cndmask_b32 v28, v12, v15, s[14:15]
    s_nop 1
    v_add_f32_dpp v28, v36, v28 quad_perm:[1,0,3,2] row_mask:0xf bank_mask:0xf
    s_waitcnt vmcnt(2)
    s_add_u32 s7, s7, 8192
    s_and_b32 s7, s7, 0x3ffff
    buffer_load_dwordx4 v[104:107], v2, s[52:55], s7 offen nt
    v_mfma_f32_16x16x32_bf16 v[12:15], v[120:123], v[4:7], 0
    v_mfma_f32_16x16x32_bf16 v[12:15], v[124:127], v[8:11], v[12:15]
    v_cndmask_b32 v36, v18, v17, s[14:15]
    v_cndmask_b32 v29, v16, v19, s[14:15]
    s_nop 1
    v_add_f32_dpp v29, v36, v29 quad_perm:[1,0,3,2] row_mask:0xf bank_mask:0xf
    v_mfma_f32_16x16x32_bf16 v[16:19], v[128:131], v[4:7], 0
    v_mfma_f32_16x16x32_bf16 v[16:19], v[132:135], v[8:11], v[16:19]
    s_nop 0
    v_cndmask_b32 v36, v14, v13, s[14:15]
    v_cndmask_b32 v30, v12, v15, s[14:15]
    s_nop 1
    v_add_f32_dpp v30, v36, v30 quad_perm:[1,0,3,2] row_mask:0xf bank_mask:0xf
    v_mfma_f32_16x16x32_bf16 v[12:15], v[136:139], v[4:7], 0
    v_mfma_f32_16x16x32_bf16 v[12:15], v[140:143], v[8:11], v[12:15]
    v_cndmask_b32 v36, v18, v17, s[14:15]
    v_cndmask_b32 v31, v16, v19, s[14:15]
    s_nop 1
    v_add_f32_dpp v31, v36, v31 quad_perm:[1,0,3,2] row_mask:0xf bank_mask:0xf
    v_mfma_f32_16x16x32_bf16 v[16:19], v[144:147], v[4:7], 0
    v_mfma_f32_16x16x32_bf16 v[16:19], v[148:151], v[8:11], v[16:19]
    s_nop 0
    v_cndmask_b32 v36, v14, v13, s[14:15]
    v_cndmask_b32 v32, v12, v15, s[14:15]
    s_nop 1
    v_add_f32_dpp v32, v36, v32 quad_perm:[1,0,3,2] row_mask:0xf bank_mask:0xf
    s_waitcnt vmcnt(2)
    s_add_u32 s7, s7, 8192
    s_and_b32 s7, s7, 0x3ffff
    buffer_load_dwordx4 v[108:111], v2, s[52:55], s7 offen nt
    v_mfma_f32_16x16x32_bf16 v[12:15], v[152:155], v[4:7], 0
    v_mfma_f32_16x16x32_bf16 v[12:15], v[156:159], v[8:11], v[12:15]
    v_cndmask_b32 v36, v18, v17, s[14:15]
    v_cndmask_b32 v33, v16, v19, s[14:15]
    s_nop 1
    v_add_f32_dpp v33, v36, v33 quad_perm:[1,0,3,2] row_mask:0xf bank_mask:0xf
    v_mfma_f32_16x16x32_bf16 v[16:19], v[160:163], v[4:7], 0
    v_mfma_f32_16x16x32_bf16 v[16:19], v[164:167], v[8:11], v[16:19]
    s_nop 0
    v_cndmask_b32 v36, v14, v13, s[14:15]
    v_cndmask_b32 v34, v12, v15, s[14:15]
    s_nop 1
    v_add_f32_dpp v34, v36, v34 quad_perm:[1,0,3,2] row_mask:0xf bank_mask:0xf
    s_nop 1
    v_cndmask_b32 v36, v18, v17, s[14:15]
    v_cndmask_b32 v35, v16, v19, s[14:15]
    s_nop 1
    v_add_f32_dpp v35, v36, v35 quad_perm:[1,0,3,2] row_mask:0xf bank_mask:0xf
    s_mov_b32 s4, 0x3db504f3
    v_cvt_pk_bf16_f32 v36, v20, v21
    v_lshlrev_b32 v20, 16, v36
    v_and_b32 v21, 0xffff0000, v36
    v_mul_f32 v20, s4, v20
    v_mul_f32 v21, s4, v21
    v_cvt_pk_bf16_f32 v38, v20, v21
    v_lshlrev_b32 v20, 16, v38
    v_and_b32 v21, 0xffff0000, v38
    v_cvt_pk_bf16_f32 v37, v22, v23
    v_lshlrev_b32 v22, 16, v37
    v_and_b32 v23, 0xffff0000, v37
    v_mul_f32 v22, s4, v22
    v_mul_f32 v23, s4, v23
    v_cvt_pk_bf16_f32 v39, v22, v23
    v_lshlrev_b32 v22, 16, v39
    v_and_b32 v23, 0xffff0000, v39
    v_cvt_pk_bf16_f32 v36, v24, v25
    v_lshlrev_b32 v24, 16, v36
    v_and_b32 v25, 0xffff0000, v36
    v_mul_f32 v24, s4, v24
    v_mul_f32 v25, s4, v25
    v_cvt_pk_bf16_f32 v38, v24, v25
    v_lshlrev_b32 v24, 16, v38
    v_and_b32 v25, 0xffff0000, v38
    v_cvt_pk_bf16_f32 v37, v26, v27
    v_lshlrev_b32 v26, 16, v37
    v_and_b32 v27, 0xffff0000, v37
    v_mul_f32 v26, s4, v26
    v_mul_f32 v27, s4, v27
    v_cvt_pk_bf16_f32 v39, v26, v27
    v_lshlrev_b32 v26, 16, v39
    v_and_b32 v27, 0xffff0000, v39
    v_cvt_pk_bf16_f32 v36, v28, v29
    v_lshlrev_b32 v28, 16, v36
    v_and_b32 v29, 0xffff0000, v36
    v_mul_f32 v28, s4, v28
    v_mul_f32 v29, s4, v29
    v_cvt_pk_bf16_f32 v38, v28, v29
    v_lshlrev_b32 v28, 16, v38
    v_and_b32 v29, 0xffff0000, v38
    v_cvt_pk_bf16_f32 v37, v30, v31
    v_lshlrev_b32 v30, 16, v37
    v_and_b32 v31, 0xffff0000, v37
    v_mul_f32 v30, s4, v30
    v_mul_f32 v31, s4, v31
    v_cvt_pk_bf16_f32 v39, v30, v31
    v_lshlrev_b32 v30, 16, v39
    v_and_b32 v31, 0xffff0000, v39
    v_cvt_pk_bf16_f32 v36, v32, v33
    v_lshlrev_b32 v32, 16, v36
    v_and_b32 v33, 0xffff0000, v36
    v_mul_f32 v32, s4, v32
    v_mul_f32 v33, s4, v33
    v_cvt_pk_bf16_f32 v38, v32, v33
    v_lshlrev_b32 v32, 16, v38
    v_and_b32 v33, 0xffff0000, v38
    v_cvt_pk_bf16_f32 v37, v34, v35
    v_lshlrev_b32 v34, 16, v37
    v_and_b32 v35, 0xffff0000, v37
    v_mul_f32 v34, s4, v34
    v_mul_f32 v35, s4, v35
    v_cvt_pk_bf16_f32 v39, v34, v35
    v_lshlrev_b32 v34, 16, v39
    v_and_b32 v35, 0xffff0000, v39
    v_max3_f32 v12, v20, v21, v22
    v_max3_f32 v12, v12, v23, v24
    v_max3_f32 v12, v12, v25, v26
    v_max3_f32 v12, v12, v27, v28
    v_max3_f32 v12, v12, v29, v30
    v_max3_f32 v12, v12, v31, v32
    v_max3_f32 v12, v12, v33, v34
    v_max_f32 v12, v12, v35
    s_nop 1
    v_max_f32_dpp v12, v12, v12 quad_perm:[1,0,3,2] row_mask:0xf bank_mask:0xf
    v_mov_b32 v36, v12
    s_nop 1
    v_permlane16_swap_b32 v12, v36
    v_max_f32 v12, v12, v36
    v_mov_b32 v36, v12
    s_nop 1
    v_permlane32_swap_b32 v12, v36
    v_max_f32 v12, v12, v36
    s_waitcnt vmcnt(2)
    s_add_u32 s7, s7, 8192
    s_and_b32 s7, s7, 0x3ffff
    buffer_load_dwordx4 v[112:115], v2, s[52:55], s7 offen nt
    s_mov_b32 s4, 0x3fb8aa3b
    v_sub_f32 v20, v20, v12
    v_sub_f32 v21, v21, v12
    v_sub_f32 v22, v22, v12
    v_sub_f32 v23, v23, v12
    v_sub_f32 v24, v24, v12
    v_sub_f32 v25, v25, v12
    v_sub_f32 v26, v26, v12
    v_sub_f32 v27, v27, v12
    v_sub_f32 v28, v28, v12
    v_sub_f32 v29, v29, v12
    v_sub_f32 v30, v30, v12
    v_sub_f32 v31, v31, v12
    v_sub_f32 v32, v32, v12
    v_sub_f32 v33, v33, v12
    v_sub_f32 v34, v34, v12
    v_sub_f32 v35, v35, v12
    v_mul_f32 v20, s4, v20
    v_mul_f32 v21, s4, v21
    v_mul_f32 v22, s4, v22
    v_mul_f32 v23, s4, v23
    v_mul_f32 v24, s4, v24
    v_mul_f32 v25, s4, v25
    v_mul_f32 v26, s4, v26
    v_mul_f32 v27, s4, v27
    v_mul_f32 v28, s4, v28
    v_mul_f32 v29, s4, v29
    v_mul_f32 v30, s4, v30
    v_mul_f32 v31, s4, v31
    v_mul_f32 v32, s4, v32
    v_mul_f32 v33, s4, v33
    v_mul_f32 v34, s4, v34
    v_mul_f32 v35, s4, v35
    v_exp_f32 v20, v20
    v_exp_f32 v21, v21
    v_exp_f32 v22, v22
    v_exp_f32 v23, v23
    v_exp_f32 v24, v24
    v_exp_f32 v25, v25
    v_exp_f32 v26, v26
    v_exp_f32 v27, v27
    v_exp_f32 v28, v28
    v_exp_f32 v29, v29
    v_exp_f32 v30, v30
    v_exp_f32 v31, v31
    v_exp_f32 v32, v32
    v_exp_f32 v33, v33
    v_exp_f32 v34, v34
    v_exp_f32 v35, v35
    v_add_f32 v13, v20, v21
    v_add_f32 v13, v13, v22
    v_add_f32 v13, v13, v23
    v_add_f32 v13, v13, v24
    v_add_f32 v13, v13, v25
    v_add_f32 v13, v13, v26
    v_add_f32 v13, v13, v27
    v_add_f32 v13, v13, v28
    v_add_f32 v13, v13, v29
    v_add_f32 v13, v13, v30
    v_add_f32 v13, v13, v31
    v_add_f32 v13, v13, v32
    v_add_f32 v13, v13, v33
    v_add_f32 v13, v13, v34
    v_add_f32 v13, v13, v35
    v_cvt_pk_bf16_f32 v20, v20, v20
    v_cvt_pk_bf16_f32 v21, v21, v21
    v_cvt_pk_bf16_f32 v22, v22, v22
    v_cvt_pk_bf16_f32 v23, v23, v23
    v_cvt_pk_bf16_f32 v24, v24, v24
    v_cvt_pk_bf16_f32 v25, v25, v25
    v_cvt_pk_bf16_f32 v26, v26, v26
    v_cvt_pk_bf16_f32 v27, v27, v27
    v_cvt_pk_bf16_f32 v28, v28, v28
    v_cvt_pk_bf16_f32 v29, v29, v29
    v_cvt_pk_bf16_f32 v30, v30, v30
    v_cvt_pk_bf16_f32 v31, v31, v31
    v_cvt_pk_bf16_f32 v32, v32, v32
    v_cvt_pk_bf16_f32 v33, v33, v33
    v_cvt_pk_bf16_f32 v34, v34, v34
    v_cvt_pk_bf16_f32 v35, v35, v35
    v_and_b32 v20, v3, v20
    v_and_b32 v21, v3, v21
    v_and_b32 v22, v3, v22
    v_and_b32 v23, v3, v23
    v_and_b32 v24, v3, v24
    v_and_b32 v25, v3, v25
    v_and_b32 v26, v3, v26
    v_and_b32 v27, v3, v27
    v_and_b32 v28, v3, v28
    v_and_b32 v29, v3, v29
    v_and_b32 v30, v3, v30
    v_and_b32 v31, v3, v31
    v_and_b32 v32, v3, v32
    v_and_b32 v33, v3, v33
    v_and_b32 v34, v3, v34
    v_and_b32 v35, v3, v35
    v_add_f32_dpp v13, v13, v13 quad_perm:[1,0,3,2] row_mask:0xf bank_mask:0xf
    v_mov_b32 v36, v13
    s_nop 1
    v_permlane16_swap_b32 v13, v36
    v_add_f32 v13, v13, v36
    v_mov_b32 v36, v13
    s_nop 1
    v_permlane32_swap_b32 v13, v36
    v_add_f32 v13, v13, v36
    s_bfe_u32 s4, s6, 0x30000
    s_lshl_b32 s4, s4, 6
    v_lshl_add_u32 v14, v0, 2, s4
    s_mov_b64 exec, 0x5555
    ds_write_b64 v14, v[12:13] offset:2048
    s_mov_b64 exec, -1
    s_waitcnt vmcnt(2)
    s_add_u32 s7, s7, 8192
    s_and_b32 s7, s7, 0x3ffff
    buffer_load_dwordx4 v[116:119], v2, s[52:55], s7 offen nt
    v_mov_b32 v36, 0
    v_mov_b32 v37, 1
    s_waitcnt lgkmcnt(0)
    s_mov_b64 exec, 1
    ds_add_u32 v36, v37 offset:2824
    s_mov_b64 exec, -1
    s_waitcnt vmcnt(6)
    v_add_u32 v4, s62, v2
    ds_read_b128 v[40:43], v4 offset:0
    ds_read_b128 v[44:47], v4 offset:1024
    ds_read_b128 v[48:51], v4 offset:2048
    ds_read_b128 v[52:55], v4 offset:3072
    ds_read_b128 v[56:59], v4 offset:4096
    ds_read_b128 v[60:63], v4 offset:5120
    ds_read_b128 v[64:67], v4 offset:6144
    ds_read_b128 v[68:71], v4 offset:7168
    ds_read_b128 v[72:75], v4 offset:8192
    ds_read_b128 v[76:79], v4 offset:9216
    ds_read_b128 v[80:83], v4 offset:10240
    ds_read_b128 v[84:87], v4 offset:11264
    ds_read_b128 v[88:91], v4 offset:12288
    ds_read_b128 v[92:95], v4 offset:13312
    s_waitcnt lgkmcnt(0)
    s_waitcnt vmcnt(12)
    v_perm_b32 v4, v44, v40, s12
    v_perm_b32 v8, v44, v40, s13
    v_perm_b32 v5, v52, v48, s12
    v_perm_b32 v9, v52, v48, s13
    v_perm_b32 v6, v60, v56, s12
    v_perm_b32 v10, v60, v56, s13
    v_perm_b32 v7, v68, v64, s12
    v_perm_b32 v11, v68, v64, s13
    s_nop 0
    v_mfma_f32_16x16x32_bf16 v[136:139], v[20:23], v[4:7], 0
    v_mfma_f32_16x16x32_bf16 v[140:143], v[20:23], v[8:11], 0
    v_perm_b32 v12, v45, v41, s12
    v_perm_b32 v16, v45, v41, s13
    v_perm_b32 v13, v53, v49, s12
    v_perm_b32 v17, v53, v49, s13
    v_perm_b32 v14, v61, v57, s12
    v_perm_b32 v18, v61, v57, s13
    v_perm_b32 v15, v69, v65, s12
    v_perm_b32 v19, v69, v65, s13
    s_nop 0
    v_mfma_f32_16x16x32_bf16 v[144:147], v[20:23], v[12:15], 0
    v_mfma_f32_16x16x32_bf16 v[148:151], v[20:23], v[16:19], 0
    v_perm_b32 v4, v46, v42, s12
    v_perm_b32 v8, v46, v42, s13
    v_perm_b32 v5, v54, v50, s12
    v_perm_b32 v9, v54, v50, s13
    v_perm_b32 v6, v62, v58, s12
    v_perm_b32 v10, v62, v58, s13
    v_perm_b32 v7, v70, v66, s12
    v_perm_b32 v11, v70, v66, s13
    s_nop 0
    v_mfma_f32_16x16x32_bf16 v[152:155], v[20:23], v[4:7], 0
    v_mfma_f32_16x16x32_bf16 v[156:159], v[20:23], v[8:11], 0
    v_perm_b32 v12, v47, v43, s12
    v_perm_b32 v16, v47, v43, s13
    v_perm_b32 v13, v55, v51, s12
    v_perm_b32 v17, v55, v51, s13
    v_perm_b32 v14, v63, v59, s12
    v_perm_b32 v18, v63, v59, s13
    v_perm_b32 v15, v71, v67, s12
    v_perm_b32 v19, v71, v67, s13
    s_nop 0
    v_mfma_f32_16x16x32_bf16 v[160:163], v[20:23], v[12:15], 0
    v_mfma_f32_16x16x32_bf16 v[164:167], v[20:23], v[16:19], 0
    s_waitcnt vmcnt(4)
    v_perm_b32 v4, v76, v72, s12
    v_perm_b32 v8, v76, v72, s13
    v_perm_b32 v5, v84, v80, s12
    v_perm_b32 v9, v84, v80, s13
    v_perm_b32 v6, v92, v88, s12
    v_perm_b32 v10, v92, v88, s13
    v_perm_b32 v7, v100, v96, s12
    v_perm_b32 v11, v100, v96, s13
    s_nop 0
    v_mfma_f32_16x16x32_bf16 v[136:139], v[24:27], v[4:7], v[136:139]
    v_mfma_f32_16x16x32_bf16 v[140:143], v[24:27], v[8:11], v[140:143]
    v_perm_b32 v12, v77, v73, s12
    v_perm_b32 v16, v77, v73, s13
    v_perm_b32 v13, v85, v81, s12
    v_perm_b32 v17, v85, v81, s13
    v_perm_b32 v14, v93, v89, s12
    v_perm_b32 v18, v93, v89, s13
    v_perm_b32 v15, v101, v97, s12
    v_perm_b32 v19, v101, v97, s13
    s_nop 0
    v_mfma_f32_16x16x32_bf16 v[144:147], v[24:27], v[12:15], v[144:147]
    v_mfma_f32_16x16x32_bf16 v[148:151], v[24:27], v[16:19], v[148:151]
    v_perm_b32 v4, v78, v74, s12
    v_perm_b32 v8, v78, v74, s13
    v_perm_b32 v5, v86, v82, s12
    v_perm_b32 v9, v86, v82, s13
    v_perm_b32 v6, v94, v90, s12
    v_perm_b32 v10, v94, v90, s13
    v_perm_b32 v7, v102, v98, s12
    v_perm_b32 v11, v102, v98, s13
    s_nop 0
    v_mfma_f32_16x16x32_bf16 v[152:155], v[24:27], v[4:7], v[152:155]
    v_mfma_f32_16x16x32_bf16 v[156:159], v[24:27], v[8:11], v[156:159]
    v_perm_b32 v12, v79, v75, s12
    v_perm_b32 v16, v79, v75, s13
    v_perm_b32 v13, v87, v83, s12
    v_perm_b32 v17, v87, v83, s13
    v_perm_b32 v14, v95, v91, s12
    v_perm_b32 v18, v95, v91, s13
    v_perm_b32 v15, v103, v99, s12
    v_perm_b32 v19, v103, v99, s13
    s_nop 0
    v_mfma_f32_16x16x32_bf16 v[160:163], v[24:27], v[12:15], v[160:163]
    v_mfma_f32_16x16x32_bf16 v[164:167], v[24:27], v[16:19], v[164:167]
    s_waitcnt vmcnt(2)
    s_add_u32 s7, s7, 8192
    s_and_b32 s7, s7, 0x3ffff
    buffer_load_dwordx4 v[120:123], v2, s[52:55], s7 offen nt
    v_mov_b32 v36, 0
    v_mov_b32 v37, 1
    s_waitcnt lgkmcnt(0)
    s_mov_b64 exec, 1
    ds_add_u32 v36, v37 offset:2840
    s_mov_b64 exec, -1
    s_waitcnt vmcnt(2)
    s_add_u32 s7, s7, 8192
    s_and_b32 s7, s7, 0x3ffff
    buffer_load_dwordx4 v[124:127], v2, s[52:55], s7 offen nt
    s_waitcnt vmcnt(2)
    s_add_u32 s7, s7, 8192
    s_and_b32 s7, s7, 0x3ffff
    buffer_load_dwordx4 v[128:131], v2, s[52:55], s7 offen nt
    s_waitcnt vmcnt(2)
    s_add_u32 s7, s7, 8192
    s_and_b32 s7, s7, 0x3ffff
    buffer_load_dwordx4 v[132:135], v2, s[52:55], s7 offen nt
    s_waitcnt vmcnt(3)
    s_add_u32 s7, s7, 8192
    s_and_b32 s7, s7, 0x3ffff
    buffer_load_dwordx4 v[40:43], v2, s[52:55], s7 offen nt
    s_waitcnt vmcnt(3)
    s_add_u32 s7, s7, 8192
    s_and_b32 s7, s7, 0x3ffff
    buffer_load_dwordx4 v[44:47], v2, s[52:55], s7 offen nt
    s_waitcnt vmcnt(3)
    s_add_u32 s7, s7, 8192
    s_and_b32 s7, s7, 0x3ffff
    buffer_load_dwordx4 v[48:51], v2, s[52:55], s7 offen nt
    s_waitcnt vmcnt(3)
    s_add_u32 s7, s7, 8192
    s_and_b32 s7, s7, 0x3ffff
    buffer_load_dwordx4 v[52:55], v2, s[52:55], s7 offen nt
    s_waitcnt vmcnt(4)
    v_perm_b32 v4, v108, v104, s12
    v_perm_b32 v8, v108, v104, s13
    v_perm_b32 v5, v116, v112, s12
    v_perm_b32 v9, v116, v112, s13
    v_perm_b32 v6, v124, v120, s12
    v_perm_b32 v10, v124, v120, s13
    v_perm_b32 v7, v132, v128, s12
    v_perm_b32 v11, v132, v128, s13
    s_nop 0
    v_mfma_f32_16x16x32_bf16 v[136:139], v[28:31], v[4:7], v[136:139]
    v_mfma_f32_16x16x32_bf16 v[140:143], v[28:31], v[8:11], v[140:143]
    v_perm_b32 v12, v109, v105, s12
    v_perm_b32 v16, v109, v105, s13
    v_perm_b32 v13, v117, v113, s12
    v_perm_b32 v17, v117, v113, s13
    v_perm_b32 v14, v125, v121, s12
    v_perm_b32 v18, v125, v121, s13
    v_perm_b32 v15, v133, v129, s12
    v_perm_b32 v19, v133, v129, s13
    s_nop 0
    v_mfma_f32_16x16x32_bf16 v[144:147], v[28:31], v[12:15], v[144:147]
    v_mfma_f32_16x16x32_bf16 v[148:151], v[28:31], v[16:19], v[148:151]
    v_perm_b32 v4, v110, v106, s12
    v_perm_b32 v8, v110, v106, s13
    v_perm_b32 v5, v118, v114, s12
    v_perm_b32 v9, v118, v114, s13
    v_perm_b32 v6, v126, v122, s12
    v_perm_b32 v10, v126, v122, s13
    v_perm_b32 v7, v134, v130, s12
    v_perm_b32 v11, v134, v130, s13
    s_nop 0
    v_mfma_f32_16x16x32_bf16 v[152:155], v[28:31], v[4:7], v[152:155]
    v_mfma_f32_16x16x32_bf16 v[156:159], v[28:31], v[8:11], v[156:159]
    v_perm_b32 v12, v111, v107, s12
    v_perm_b32 v16, v111, v107, s13
    v_perm_b32 v13, v119, v115, s12
    v_perm_b32 v17, v119, v115, s13
    v_perm_b32 v14, v127, v123, s12
    v_perm_b32 v18, v127, v123, s13
    v_perm_b32 v15, v135, v131, s12
    v_perm_b32 v19, v135, v131, s13
    s_nop 0
    v_mfma_f32_16x16x32_bf16 v[160:163], v[28:31], v[12:15], v[160:163]
    v_mfma_f32_16x16x32_bf16 v[164:167], v[28:31], v[16:19], v[164:167]
    s_waitcnt vmcnt(3)
    s_add_u32 s7, s7, 8192
    s_and_b32 s7, s7, 0x3ffff
    buffer_load_dwordx4 v[56:59], v2, s[52:55], s7 offen nt
    s_waitcnt vmcnt(3)
    s_add_u32 s7, s7, 8192
    s_and_b32 s7, s7, 0x3ffff
    buffer_load_dwordx4 v[60:63], v2, s[52:55], s7 offen nt
    s_waitcnt vmcnt(3)
    s_add_u32 s7, s7, 8192
    s_and_b32 s7, s7, 0x3ffff
    buffer_load_dwordx4 v[64:67], v2, s[52:55], s7 offen nt
    s_waitcnt vmcnt(3)
    s_add_u32 s7, s7, 8192
    s_and_b32 s7, s7, 0x3ffff
    buffer_load_dwordx4 v[68:71], v2, s[52:55], s7 offen nt
    v_mov_b32 v36, 0
    v_mov_b32 v37, 1
    s_waitcnt lgkmcnt(0)
    s_mov_b64 exec, 1
    ds_add_u32 v36, v37 offset:2836
    s_mov_b64 exec, -1
    v_mov_b32 v36, 0
    v_mov_b32 v37, 1
    s_waitcnt lgkmcnt(0)
    s_mov_b64 exec, 1
    ds_add_u32 v36, v37 offset:2828
    s_mov_b64 exec, -1
    s_bfe_u32 s4, s6, 0x30000
    s_mul_i32 s4, s4, 14336
    s_add_u32 s4, s4, 33792
    v_lshrrev_b32 v5, 4, v0
    v_lshl_add_u32 v4, v5, 10, s4
    v_and_b32 v5, 15, v0
    v_lshl_add_u32 v4, v5, 4, v4
    v_xor_b32 v5, 128, v4
    s_waitcnt vmcnt(6)
    v_perm_b32 v72, v44, v40, s12
    v_perm_b32 v76, v44, v40, s13
    v_perm_b32 v80, v45, v41, s12
    v_perm_b32 v84, v45, v41, s13
    v_perm_b32 v88, v46, v42, s12
    v_perm_b32 v92, v46, v42, s13
    v_perm_b32 v96, v47, v43, s12
    v_perm_b32 v100, v47, v43, s13
    s_waitcnt vmcnt(4)
    v_perm_b32 v73, v52, v48, s12
    v_perm_b32 v77, v52, v48, s13
    v_perm_b32 v81, v53, v49, s12
    v_perm_b32 v85, v53, v49, s13
    v_perm_b32 v89, v54, v50, s12
    v_perm_b32 v93, v54, v50, s13
    v_perm_b32 v97, v55, v51, s12
    v_perm_b32 v101, v55, v51, s13
    s_waitcnt vmcnt(2)
    v_perm_b32 v74, v60, v56, s12
    v_perm_b32 v78, v60, v56, s13
    v_perm_b32 v82, v61, v57, s12
    v_perm_b32 v86, v61, v57, s13
    v_perm_b32 v90, v62, v58, s12
    v_perm_b32 v94, v62, v58, s13
    v_perm_b32 v98, v63, v59, s12
    v_perm_b32 v102, v63, v59, s13
    s_waitcnt vmcnt(0)
    v_perm_b32 v75, v68, v64, s12
    v_perm_b32 v79, v68, v64, s13
    v_perm_b32 v83, v69, v65, s12
    v_perm_b32 v87, v69, v65, s13
    v_mfma_f32_16x16x32_bf16 v[136:139], v[32:35], v[72:75], v[136:139]
    v_mfma_f32_16x16x32_bf16 v[140:143], v[32:35], v[76:79], v[140:143]
    v_perm_b32 v91, v70, v66, s12
    v_perm_b32 v95, v70, v66, s13
    v_mfma_f32_16x16x32_bf16 v[144:147], v[32:35], v[80:83], v[144:147]
    v_mfma_f32_16x16x32_bf16 v[148:151], v[32:35], v[84:87], v[148:151]
    v_perm_b32 v99, v71, v67, s12
    v_perm_b32 v103, v71, v67, s13
    v_mfma_f32_16x16x32_bf16 v[152:155], v[32:35], v[88:91], v[152:155]
    v_mfma_f32_16x16x32_bf16 v[156:159], v[32:35], v[92:95], v[156:159]
    v_mfma_f32_16x16x32_bf16 v[160:163], v[32:35], v[96:99], v[160:163]
    v_mfma_f32_16x16x32_bf16 v[164:167], v[32:35], v[100:103], v[164:167]
    v_add_f32 v40, v136, v137
    v_add_f32 v48, v138, v139
    v_add_f32 v41, v140, v141
    v_add_f32 v49, v142, v143
    v_add_f32 v42, v144, v145
    v_add_f32 v50, v146, v147
    v_add_f32 v43, v148, v149
    v_add_f32 v51, v150, v151
    ds_write_b128 v4, v[40:43] offset:0
    ds_write_b128 v4, v[48:51] offset:512
    v_add_f32 v44, v152, v153
    v_add_f32 v52, v154, v155
    v_add_f32 v45, v156, v157
    v_add_f32 v53, v158, v159
    v_add_f32 v46, v160, v161
    v_add_f32 v54, v162, v163
    v_add_f32 v47, v164, v165
    v_add_f32 v55, v166, v167
    ds_write_b128 v5, v[44:47] offset:256
    ds_write_b128 v5, v[52:55] offset:768
    s_waitcnt lgkmcnt(0)
    s_barrier
L_s9:
    s_endpgm
L_ctrl:
    s_setprio 3
    v_mov_b32 v3, 0xff
    s_bfe_u32 s4, s2, 0x40004
    s_mul_i32 s4, s4, 786432
    s_bfe_u32 s5, s2, 0x40000
    s_lshl_b32 s5, s5, 8
    s_add_u32 s4, s4, s5
    v_lshrrev_b32 v15, 4, v0
    v_mul_u32_u24 v15, 98304, v15
    v_add_u32 v12, s4, v15
    v_and_b32 v15, 15, v0
    v_lshl_add_u32 v12, v15, 4, v12
    s_bfe_u32 s4, s2, 0x40004
    s_lshl_b32 s4, s4, 7
    v_bfe_u32 v15, v0, 2, 1
    v_lshl_add_u32 v13, v15, 11, s4
    v_lshrrev_b32 v15, 4, v0
    v_lshl_add_u32 v13, v15, 4, v13
    v_mov_b32 v14, 0
    v_lshlrev_b32 v15, 2, v0
    s_mov_b64 exec, 0xffff
    ds_write_b32 v15, v14 offset:2816
    s_mov_b64 exec, -1
    s_bfe_u32 s4, s2, 0x30005
    s_lshl_b32 s4, s4, 20
    s_bfe_u32 s5, s3, 0x20000
    s_lshl_b32 s5, s5, 18
    s_add_u32 s4, s4, s5
    s_bfe_u32 s5, s2, 0x30000
    s_lshl_b32 s5, s5, 10
    s_add_u32 s4, s4, s5
    s_bfe_u32 s5, s2, 0x20003
    s_lshl_b32 s5, s5, 8
    s_add_u32 s4, s4, s5
    v_lshrrev_b32 v16, 4, v0
    v_lshl_add_u32 v14, v16, 16, s4
    v_and_b32 v16, 15, v0
    v_lshl_add_u32 v14, v16, 4, v14
    s_bfe_u32 s4, s2, 0x30004
    s_mul_i32 s4, s4, 1572864
    s_bfe_u32 s5, s3, 0x20000
    s_mul_i32 s5, s5, 393216
    s_add_u32 s4, s4, s5
    s_bfe_u32 s5, s2, 0x10007
    s_lshl_b32 s5, s5, 12
    s_add_u32 s4, s4, s5
    s_bfe_u32 s5, s2, 0x40000
    s_lshl_b32 s5, s5, 8
    s_add_u32 s4, s4, s5
    s_add_u32 s4, s4, 4096
    v_lshrrev_b32 v16, 4, v0
    v_mul_u32_u24 v16, 98304, v16
    v_add_u32 v17, s4, v16
    v_and_b32 v16, 15, v0
    v_lshl_add_u32 v17, v16, 4, v17
    v_lshlrev_b32 v18, 4, v0
    s_cmp_lt_u32 s2, 64
    s_cselect_b32 s67, s3, 0
    s_waitcnt lgkmcnt(0)
    s_mov_b32 s48, s38
    s_mov_b32 s49, s39
    s_mov_b32 s50, 12582912
    s_mov_b32 s51, 0x20000
    s_cmp_lg_u32 s3, 0
    s_cbranch_scc1 L_c0
    global_load_dwordx4 v[4:7], v13, s[36:37]
    global_load_dwordx4 v[8:11], v13, s[36:37] offset:64
    buffer_load_dwordx4 v[40:43], v12, s[48:51], 0 offen nt
    s_mov_b32 s11, 12288
    buffer_load_dwordx4 v[44:47], v12, s[48:51], s11 offen nt
    s_mov_b32 s11, 24576
    buffer_load_dwordx4 v[48:51], v12, s[48:51], s11 offen nt
    s_mov_b32 s11, 36864
    buffer_load_dwordx4 v[52:55], v12, s[48:51], s11 offen nt
    s_mov_b32 s11, 49152
    buffer_load_dwordx4 v[56:59], v12, s[48:51], s11 offen nt
    s_mov_b32 s11, 61440
    buffer_load_dwordx4 v[60:63], v12, s[48:51], s11 offen nt
    s_mov_b32 s11, 73728
    buffer_load_dwordx4 v[64:67], v12, s[48:51], s11 offen nt
    s_mov_b32 s11, 86016
    buffer_load_dwordx4 v[68:71], v12, s[48:51], s11 offen nt
    s_mov_b32 s11, 393216
    buffer_load_dwordx4 v[136:139], v12, s[48:51], s11 offen nt
    s_mov_b32 s11, 405504
    buffer_load_dwordx4 v[140:143], v12, s[48:51], s11 offen nt
    s_mov_b32 s11, 417792
    buffer_load_dwordx4 v[144:147], v12, s[48:51], s11 offen nt
    s_mov_b32 s11, 430080
    buffer_load_dwordx4 v[148:151], v12, s[48:51], s11 offen nt
    s_mov_b32 s11, 442368
    buffer_load_dwordx4 v[152:155], v12, s[48:51], s11 offen nt
    s_mov_b32 s11, 454656
    buffer_load_dwordx4 v[156:159], v12, s[48:51], s11 offen nt
    s_mov_b32 s11, 466944
    buffer_load_dwordx4 v[160:163], v12, s[48:51], s11 offen nt
    s_mov_b32 s11, 479232
    buffer_load_dwordx4 v[164:167], v12, s[48:51], s11 offen nt
L_c0:
    s_cmp_lg_u32 s67, 1
    s_cbranch_scc1 L_c1
    s_bfe_u32 s4, s2, 0x10003
    s_lshl_b32 s4, s4, 11
    v_lshl_add_u32 v15, v0, 4, s4
    global_load_dwordx4 v[40:43], v15, s[16:17] offset:0
    global_load_dwordx4 v[44:47], v15, s[16:17] offset:1024
    s_bfe_u32 s4, s2, 0x10003
    s_lshl_b32 s4, s4, 11
    s_bfe_u32 s5, s2, 0x30000
    s_lshl_b32 s5, s5, 8
    s_add_u32 s4, s4, s5
    s_bfe_u32 s5, s2, 0x20004
    s_lshl_b32 s5, s5, 6
    s_add_u32 s4, s4, s5
    v_and_b32 v16, 7, v0
    v_lshl_add_u32 v15, v16, 3, s4
    global_load_dwordx2 v[48:49], v15, s[16:17]
L_c1:
    s_load_dword s60, s[42:43], 0
    s_mov_b32 s52, s22
    s_mov_b32 s53, s23
    s_mov_b32 s54, 8388608
    s_mov_b32 s55, 0x20000
    buffer_load_dwordx4 v[104:107], v17, s[48:51], 0 offen nt
    s_mov_b32 s11, 12288
    buffer_load_dwordx4 v[108:111], v17, s[48:51], s11 offen nt
    s_mov_b32 s11, 24576
    buffer_load_dwordx4 v[112:115], v17, s[48:51], s11 offen nt
    s_mov_b32 s11, 36864
    buffer_load_dwordx4 v[116:119], v17, s[48:51], s11 offen nt
    s_mov_b32 s11, 49152
    buffer_load_dwordx4 v[120:123], v17, s[48:51], s11 offen nt
    s_mov_b32 s11, 61440
    buffer_load_dwordx4 v[124:127], v17, s[48:51], s11 offen nt
    s_mov_b32 s11, 73728
    buffer_load_dwordx4 v[128:131], v17, s[48:51], s11 offen nt
    s_mov_b32 s11, 86016
    buffer_load_dwordx4 v[132:135], v17, s[48:51], s11 offen nt
    s_cmp_eq_u32 s3, 0
    s_cbranch_scc1 L_c1b
    buffer_load_dwordx4 v[136:139], v14, s[52:55], 0 offen nt
    s_mov_b32 s11, 8192
    buffer_load_dwordx4 v[140:143], v14, s[52:55], s11 offen nt
    s_mov_b32 s11, 16384
    buffer_load_dwordx4 v[144:147], v14, s[52:55], s11 offen nt
    s_mov_b32 s11, 24576
    buffer_load_dwordx4 v[148:151], v14, s[52:55], s11 offen nt
    s_mov_b32 s11, 32768
    buffer_load_dwordx4 v[152:155], v14, s[52:55], s11 offen nt
    s_mov_b32 s11, 40960
    buffer_load_dwordx4 v[156:159], v14, s[52:55], s11 offen nt
    s_mov_b32 s11, 49152
    buffer_load_dwordx4 v[160:163], v14, s[52:55], s11 offen nt
    s_mov_b32 s11, 57344
    buffer_load_dwordx4 v[164:167], v14, s[52:55], s11 offen nt
L_c1b:
    s_barrier
    s_mov_b32 s14, 0
    s_mov_b32 s15, -1
    s_mov_b32 s44, s42
    s_mov_b32 s45, s43
    s_mov_b32 s46, 2555904
    s_mov_b32 s47, 0x20000
    s_bfe_u32 s4, s3, 0x20000
    s_lshl_b32 s4, s4, 10
    v_bfe_u32 v15, v0, 4, 1
    v_lshl_add_u32 v16, v15, 9, s4
    v_and_b32 v15, 15, v0
    v_lshl_add_u32 v16, v15, 5, v16
    v_lshrrev_b32 v15, 5, v0
    v_lshl_add_u32 v16, v15, 4, v16
    s_lshl_b32 s4, s3, 10
    v_add_u32 v19, s4, v18
    s_and_b32 s4, s2, 127
    s_mul_i32 s4, s4, 20
    s_add_u32 s4, s4, 14208
    s_lshl_b32 s4, s4, 16
    s_lshr_b32 s5, s2, 7
    s_lshl_b32 s5, s5, 31
    s_or_b32 s64, s4, s5
    s_lshl_b32 s6, s3, 4
    s_mov_b32 s66, 0
    s_waitcnt lgkmcnt(0)
    s_add_u32 s60, s60, 0x01010101
    s_and_b32 s56, s60, 0xff
    s_bfe_u32 s57, s60, 0x80008
    s_bfe_u32 s58, s60, 0x80010
    s_lshr_b32 s59, s60, 24
    s_cmp_lg_u32 s3, 0
    s_cbranch_scc1 L_c2
    s_waitcnt vmcnt(24)
    s_mov_b32 s4, 0xbfb8aa3b
    v_lshlrev_b32 v88, 16, v4
    v_and_b32 v89, 0xffff0000, v4
    v_lshlrev_b32 v90, 16, v5
    v_and_b32 v91, 0xffff0000, v5
    v_lshlrev_b32 v92, 16, v6
    v_and_b32 v93, 0xffff0000, v6
    v_lshlrev_b32 v94, 16, v7
    v_and_b32 v95, 0xffff0000, v7
    v_lshlrev_b32 v96, 16, v8
    v_and_b32 v97, 0xffff0000, v8
    v_lshlrev_b32 v98, 16, v9
    v_and_b32 v99, 0xffff0000, v9
    v_lshlrev_b32 v100, 16, v10
    v_and_b32 v101, 0xffff0000, v10
    v_lshlrev_b32 v102, 16, v11
    v_and_b32 v103, 0xffff0000, v11
    v_mul_f32 v72, s4, v88
    v_mul_f32 v73, s4, v89
    v_mul_f32 v74, s4, v90
    v_mul_f32 v75, s4, v91
    v_mul_f32 v76, s4, v92
    v_mul_f32 v77, s4, v93
    v_mul_f32 v78, s4, v94
    v_mul_f32 v79, s4, v95
    v_mul_f32 v80, s4, v96
    v_mul_f32 v81, s4, v97
    v_mul_f32 v82, s4, v98
    v_mul_f32 v83, s4, v99
    v_mul_f32 v84, s4, v100
    v_mul_f32 v85, s4, v101
    v_mul_f32 v86, s4, v102
    v_mul_f32 v87, s4, v103
    v_exp_f32 v72, v72
    v_exp_f32 v73, v73
    v_exp_f32 v74, v74
    v_exp_f32 v75, v75
    v_exp_f32 v76, v76
    v_exp_f32 v77, v77
    v_exp_f32 v78, v78
    v_exp_f32 v79, v79
    v_exp_f32 v80, v80
    v_exp_f32 v81, v81
    v_exp_f32 v82, v82
    v_exp_f32 v83, v83
    v_exp_f32 v84, v84
    v_exp_f32 v85, v85
    v_exp_f32 v86, v86
    v_exp_f32 v87, v87
    v_add_f32 v72, 1.0, v72
    v_add_f32 v73, 1.0, v73
    v_add_f32 v74, 1.0, v74
    v_add_f32 v75, 1.0, v75
    v_add_f32 v76, 1.0, v76
    v_add_f32 v77, 1.0, v77
    v_add_f32 v78, 1.0, v78
    v_add_f32 v79, 1.0, v79
    v_add_f32 v80, 1.0, v80
    v_add_f32 v81, 1.0, v81
    v_add_f32 v82, 1.0, v82
    v_add_f32 v83, 1.0, v83
    v_add_f32 v84, 1.0, v84
    v_add_f32 v85, 1.0, v85
    v_add_f32 v86, 1.0, v86
    v_add_f32 v87, 1.0, v87
    v_rcp_f32 v72, v72
    v_rcp_f32 v73, v73
    v_rcp_f32 v74, v74
    v_rcp_f32 v75, v75
    v_rcp_f32 v76, v76
    v_rcp_f32 v77, v77
    v_rcp_f32 v78, v78
    v_rcp_f32 v79, v79
    v_rcp_f32 v80, v80
    v_rcp_f32 v81, v81
    v_rcp_f32 v82, v82
    v_rcp_f32 v83, v83
    v_rcp_f32 v84, v84
    v_rcp_f32 v85, v85
    v_rcp_f32 v86, v86
    v_rcp_f32 v87, v87
    v_mul_f32 v72, v72, v88
    v_mul_f32 v73, v73, v89
    v_mul_f32 v74, v74, v90
    v_mul_f32 v75, v75, v91
    v_mul_f32 v76, v76, v92
    v_mul_f32 v77, v77, v93
    v_mul_f32 v78, v78, v94
    v_mul_f32 v79, v79, v95
    v_mul_f32 v80, v80, v96
    v_mul_f32 v81, v81, v97
    v_mul_f32 v82, v82, v98
    v_mul_f32 v83, v83, v99
    v_mul_f32 v84, v84, v100
    v_mul_f32 v85, v85, v101
    v_mul_f32 v86, v86, v102
    v_mul_f32 v87, v87, v103
    v_cvt_pk_bf16_f32 v4, v72, v73
    v_cvt_pk_bf16_f32 v5, v74, v75
    v_cvt_pk_bf16_f32 v6, v76, v77
    v_cvt_pk_bf16_f32 v7, v78, v79
    v_cvt_pk_bf16_f32 v8, v80, v81
    v_cvt_pk_bf16_f32 v9, v82, v83
    v_cvt_pk_bf16_f32 v10, v84, v85
    v_cvt_pk_bf16_f32 v11, v86, v87
    s_bfe_u32 s4, s2, 0x40000
    s_mul_i32 s4, s4, 135168
    s_bfe_u32 s5, s2, 0x40004
    s_mul_i32 s5, s5, 8448
    s_add_u32 s4, s4, s5
    s_add_u32 s4, s4, 393216
    v_add_u32 v12, s4, v18
    s_waitcnt vmcnt(16)
    v_perm_b32 v24, v44, v40, s12
    v_perm_b32 v28, v44, v40, s13
    v_perm_b32 v25, v52, v48, s12
    v_perm_b32 v29, v52, v48, s13
    v_perm_b32 v26, v60, v56, s12
    v_perm_b32 v30, v60, v56, s13
    v_perm_b32 v27, v68, v64, s12
    v_perm_b32 v31, v68, v64, s13
    s_nop 0
    v_mfma_f32_16x16x32_bf16 v[72:75], v[4:7], v[24:27], 0
    v_mfma_f32_16x16x32_bf16 v[76:79], v[4:7], v[28:31], 0
    v_perm_b32 v32, v45, v41, s12
    v_perm_b32 v36, v45, v41, s13
    v_perm_b32 v33, v53, v49, s12
    v_perm_b32 v37, v53, v49, s13
    v_perm_b32 v34, v61, v57, s12
    v_perm_b32 v38, v61, v57, s13
    v_perm_b32 v35, v69, v65, s12
    v_perm_b32 v39, v69, v65, s13
    s_nop 0
    v_mfma_f32_16x16x32_bf16 v[80:83], v[4:7], v[32:35], 0
    v_mfma_f32_16x16x32_bf16 v[84:87], v[4:7], v[36:39], 0
    v_perm_b32 v24, v46, v42, s12
    v_perm_b32 v28, v46, v42, s13
    v_perm_b32 v25, v54, v50, s12
    v_perm_b32 v29, v54, v50, s13
    v_perm_b32 v26, v62, v58, s12
    v_perm_b32 v30, v62, v58, s13
    v_perm_b32 v27, v70, v66, s12
    v_perm_b32 v31, v70, v66, s13
    s_nop 0
    v_mfma_f32_16x16x32_bf16 v[88:91], v[4:7], v[24:27], 0
    v_mfma_f32_16x16x32_bf16 v[92:95], v[4:7], v[28:31], 0
    v_perm_b32 v32, v47, v43, s12
    v_perm_b32 v36, v47, v43, s13
    v_perm_b32 v33, v55, v51, s12
    v_perm_b32 v37, v55, v51, s13
    v_perm_b32 v34, v63, v59, s12
    v_perm_b32 v38, v63, v59, s13
    v_perm_b32 v35, v71, v67, s12
    v_perm_b32 v39, v71, v67, s13
    s_nop 0
    v_mfma_f32_16x16x32_bf16 v[96:99], v[4:7], v[32:35], 0
    v_mfma_f32_16x16x32_bf16 v[100:103], v[4:7], v[36:39], 0
    s_waitcnt vmcnt(8)
    v_perm_b32 v24, v140, v136, s12
    v_perm_b32 v28, v140, v136, s13
    v_perm_b32 v25, v148, v144, s12
    v_perm_b32 v29, v148, v144, s13
    v_perm_b32 v26, v156, v152, s12
    v_perm_b32 v30, v156, v152, s13
    v_perm_b32 v27, v164, v160, s12
    v_perm_b32 v31, v164, v160, s13
    s_nop 0
    v_mfma_f32_16x16x32_bf16 v[72:75], v[8:11], v[24:27], v[72:75]
    v_mfma_f32_16x16x32_bf16 v[76:79], v[8:11], v[28:31], v[76:79]
    v_perm_b32 v32, v141, v137, s12
    v_perm_b32 v36, v141, v137, s13
    v_perm_b32 v33, v149, v145, s12
    v_perm_b32 v37, v149, v145, s13
    v_perm_b32 v34, v157, v153, s12
    v_perm_b32 v38, v157, v153, s13
    v_perm_b32 v35, v165, v161, s12
    v_perm_b32 v39, v165, v161, s13
    s_nop 0
    v_mfma_f32_16x16x32_bf16 v[80:83], v[8:11], v[32:35], v[80:83]
    v_mfma_f32_16x16x32_bf16 v[84:87], v[8:11], v[36:39], v[84:87]
    v_perm_b32 v24, v142, v138, s12
    v_perm_b32 v28, v142, v138, s13
    v_perm_b32 v25, v150, v146, s12
    v_perm_b32 v29, v150, v146, s13
    v_perm_b32 v26, v158, v154, s12
    v_perm_b32 v30, v158, v154, s13
    v_perm_b32 v27, v166, v162, s12
    v_perm_b32 v31, v166, v162, s13
    s_nop 0
    v_mfma_f32_16x16x32_bf16 v[88:91], v[8:11], v[24:27], v[88:91]
    v_mfma_f32_16x16x32_bf16 v[92:95], v[8:11], v[28:31], v[92:95]
    v_perm_b32 v32, v143, v139, s12
    v_perm_b32 v36, v143, v139, s13
    v_perm_b32 v33, v151, v147, s12
    v_perm_b32 v37, v151, v147, s13
    v_perm_b32 v34, v159, v155, s12
    v_perm_b32 v38, v159, v155, s13
    v_perm_b32 v35, v167, v163, s12
    v_perm_b32 v39, v167, v163, s13
    s_nop 0
    v_mfma_f32_16x16x32_bf16 v[96:99], v[8:11], v[32:35], v[96:99]
    v_mfma_f32_16x16x32_bf16 v[100:103], v[8:11], v[36:39], v[100:103]
    v_cndmask_b32 v24, v72, v88, s[14:15]
    v_cndmask_b32 v25, v76, v92, s[14:15]
    s_nop 4
    v_cndmask_b32 v26, v80, v96, s[14:15]
    v_cndmask_b32 v27, v84, v100, s[14:15]
    v_add_u32 v28, 0x80, v24
    v_add_u32 v29, 0x80, v25
    v_add_u32 v30, 0x80, v26
    v_add_u32 v31, 0x80, v27
    v_bfi_b32 v28, v3, s56, v28
    v_bfi_b32 v29, v3, s57, v29
    v_bfi_b32 v30, v3, s58, v30
    v_bfi_b32 v31, v3, s59, v31
    buffer_store_dwordx4 v[28:31], v12, s[44:47], 0 offen
    buffer_load_dwordx4 v[136:139], v14, s[52:55], 0 offen nt
    s_mov_b32 s11, 8192
    buffer_load_dwordx4 v[140:143], v14, s[52:55], s11 offen nt
    s_mov_b32 s11, 16384
    buffer_load_dwordx4 v[144:147], v14, s[52:55], s11 offen nt
    s_mov_b32 s11, 24576
    buffer_load_dwordx4 v[148:151], v14, s[52:55], s11 offen nt
    s_mov_b32 s11, 32768
    buffer_load_dwordx4 v[152:155], v14, s[52:55], s11 offen nt
    s_mov_b32 s11, 40960
    buffer_load_dwordx4 v[156:159], v14, s[52:55], s11 offen nt
    s_mov_b32 s11, 49152
    buffer_load_dwordx4 v[160:163], v14, s[52:55], s11 offen nt
    s_mov_b32 s11, 57344
    buffer_load_dwordx4 v[164:167], v14, s[52:55], s11 offen nt
L_c2:
    s_bfe_u32 s4, s2, 0x30004
    s_lshl_b32 s4, s4, 8
    s_bfe_u32 s5, s3, 0x20000
    s_lshl_b32 s5, s5, 6
    s_add_u32 s4, s4, s5
    v_bfe_u32 v15, v0, 2, 1
    v_lshl_add_u32 v13, v15, 11, s4
    v_lshrrev_b32 v15, 4, v0
    v_lshl_add_u32 v13, v15, 4, v13
    global_load_dwordx4 v[96:99], v13, s[36:37]
    s_mul_i32 s4, s3, 1792
    v_mul_u32_u24 v4, 28, v0
    v_add_u32 v4, s4, v4
    global_load_dwordx4 v[72:75], v4, s[28:29]
    global_load_dwordx3 v[76:78], v4, s[28:29] offset:16
    global_load_dwordx4 v[80:83], v4, s[30:31]
    global_load_dwordx3 v[84:86], v4, s[30:31] offset:16
    global_load_dwordx4 v[88:91], v4, s[32:33]
    global_load_dwordx3 v[92:94], v4, s[32:33] offset:16
    s_cmp_lg_u32 s67, 1
    s_cbranch_scc1 L_c2b
    s_waitcnt vmcnt(23)
    v_lshlrev_b32 v52, 16, v40
    v_and_b32 v53, 0xffff0000, v40
    v_lshlrev_b32 v54, 16, v41
    v_and_b32 v55, 0xffff0000, v41
    v_lshlrev_b32 v56, 16, v42
    v_and_b32 v57, 0xffff0000, v42
    v_lshlrev_b32 v58, 16, v43
    v_and_b32 v59, 0xffff0000, v43
    v_lshlrev_b32 v60, 16, v44
    v_and_b32 v61, 0xffff0000, v44
    v_lshlrev_b32 v62, 16, v45
    v_and_b32 v63, 0xffff0000, v45
    v_lshlrev_b32 v64, 16, v46
    v_and_b32 v65, 0xffff0000, v46
    v_lshlrev_b32 v66, 16, v47
    v_and_b32 v67, 0xffff0000, v47
    v_add_f32 v4, v52, v53
    v_add_f32 v4, v4, v54
    v_add_f32 v4, v4, v55
    v_add_f32 v4, v4, v56
    v_add_f32 v4, v4, v57
    v_add_f32 v4, v4, v58
    v_add_f32 v4, v4, v59
    v_add_f32 v4, v4, v60
    v_add_f32 v4, v4, v61
    v_add_f32 v4, v4, v62
    v_add_f32 v4, v4, v63
    v_add_f32 v4, v4, v64
    v_add_f32 v4, v4, v65
    v_add_f32 v4, v4, v66
    v_add_f32 v4, v4, v67
    s_nop 1
    v_add_f32_dpp v4, v4, v4 quad_perm:[1,0,3,2] row_mask:0xf bank_mask:0xf
    s_nop 1
    v_add_f32_dpp v4, v4, v4 quad_perm:[2,3,0,1] row_mask:0xf bank_mask:0xf
    s_nop 1
    v_add_f32_dpp v4, v4, v4 row_half_mirror row_mask:0xf bank_mask:0xf
    s_nop 1
    v_add_f32_dpp v4, v4, v4 row_mirror row_mask:0xf bank_mask:0xf
    v_mov_b32 v6, v4
    s_nop 1
    v_permlane16_swap_b32 v4, v6
    v_add_f32 v4, v4, v6
    v_mov_b32 v6, v4
    s_nop 1
    v_permlane32_swap_b32 v4, v6
    v_add_f32 v4, v4, v6
    v_mul_f32 v4, 0x3a800000, v4
    v_sub_f32 v6, v52, v4
    v_mul_f32 v5, v6, v6
    v_sub_f32 v7, v53, v4
    v_fmac_f32 v5, v7, v7
    v_sub_f32 v6, v54, v4
    v_fmac_f32 v5, v6, v6
    v_sub_f32 v7, v55, v4
    v_fmac_f32 v5, v7, v7
    v_sub_f32 v6, v56, v4
    v_fmac_f32 v5, v6, v6
    v_sub_f32 v7, v57, v4
    v_fmac_f32 v5, v7, v7
    v_sub_f32 v6, v58, v4
    v_fmac_f32 v5, v6, v6
    v_sub_f32 v7, v59, v4
    v_fmac_f32 v5, v7, v7
    v_sub_f32 v6, v60, v4
    v_fmac_f32 v5, v6, v6
    v_sub_f32 v7, v61, v4
    v_fmac_f32 v5, v7, v7
    v_sub_f32 v6, v62, v4
    v_fmac_f32 v5, v6, v6
    v_sub_f32 v7, v63, v4
    v_fmac_f32 v5, v7, v7
    v_sub_f32 v6, v64, v4
    v_fmac_f32 v5, v6, v6
    v_sub_f32 v7, v65, v4
    v_fmac_f32 v5, v7, v7
    v_sub_f32 v6, v66, v4
    v_fmac_f32 v5, v6, v6
    v_sub_f32 v7, v67, v4
    v_fmac_f32 v5, v7, v7
    s_nop 1
    v_add_f32_dpp v5, v5, v5 quad_perm:[1,0,3,2] row_mask:0xf bank_mask:0xf
    s_nop 1
    v_add_f32_dpp v5, v5, v5 quad_perm:[2,3,0,1] row_mask:0xf bank_mask:0xf
    s_nop 1
    v_add_f32_dpp v5, v5, v5 row_half_mirror row_mask:0xf bank_mask:0xf
    s_nop 1
    v_add_f32_dpp v5, v5, v5 row_mirror row_mask:0xf bank_mask:0xf
    v_mov_b32 v6, v5
    s_nop 1
    v_permlane16_swap_b32 v5, v6
    v_add_f32 v5, v5, v6
    v_mov_b32 v6, v5
    s_nop 1
    v_permlane32_swap_b32 v5, v6
    v_add_f32 v5, v5, v6
    v_mul_f32 v5, 0x3a800000, v5
    v_cvt_pk_bf16_f32 v6, v4, v5
    v_lshlrev_b32 v4, 16, v6
    v_and_b32 v5, 0xffff0000, v6
    v_add_f32 v5, 0x3727c5ac, v5
    v_cvt_pk_bf16_f32 v5, v5, v5
    v_and_b32 v5, 0xffff0000, v5
    v_sqrt_f32 v5, v5
    s_nop 0
    v_cvt_pk_bf16_f32 v5, v5, v5
    v_and_b32 v5, 0xffff0000, v5
    v_rcp_f32 v5, v5
    v_lshlrev_b32 v20, 16, v48
    v_and_b32 v21, 0xffff0000, v48
    v_lshlrev_b32 v22, 16, v49
    v_and_b32 v23, 0xffff0000, v49
    v_sub_f32 v20, v20, v4
    v_sub_f32 v21, v21, v4
    v_sub_f32 v22, v22, v4
    v_sub_f32 v23, v23, v4
    v_cvt_pk_bf16_f32 v6, v20, v21
    v_lshlrev_b32 v20, 16, v6
    v_and_b32 v21, 0xffff0000, v6
    v_cvt_pk_bf16_f32 v7, v22, v23
    v_lshlrev_b32 v22, 16, v7
    v_and_b32 v23, 0xffff0000, v7
    v_mul_f32 v20, v20, v5
    v_mul_f32 v21, v21, v5
    v_mul_f32 v22, v22, v5
    v_mul_f32 v23, v23, v5
    v_cvt_pk_bf16_f32 v6, v20, v21
    v_lshlrev_b32 v20, 16, v6
    v_and_b32 v21, 0xffff0000, v6
    v_cvt_pk_bf16_f32 v7, v22, v23
    v_lshlrev_b32 v22, 16, v7
    v_and_b32 v23, 0xffff0000, v7
L_c2b:
    s_waitcnt vmcnt(6)
    s_mov_b32 s4, 0xbfb8aa3b
    v_lshlrev_b32 v48, 16, v96
    v_and_b32 v49, 0xffff0000, v96
    v_lshlrev_b32 v50, 16, v97
    v_and_b32 v51, 0xffff0000, v97
    v_lshlrev_b32 v52, 16, v98
    v_and_b32 v53, 0xffff0000, v98
    v_lshlrev_b32 v54, 16, v99
    v_and_b32 v55, 0xffff0000, v99
    v_mul_f32 v40, s4, v48
    v_mul_f32 v41, s4, v49
    v_mul_f32 v42, s4, v50
    v_mul_f32 v43, s4, v51
    v_mul_f32 v44, s4, v52
    v_mul_f32 v45, s4, v53
    v_mul_f32 v46, s4, v54
    v_mul_f32 v47, s4, v55
    v_exp_f32 v40, v40
    v_exp_f32 v41, v41
    v_exp_f32 v42, v42
    v_exp_f32 v43, v43
    v_exp_f32 v44, v44
    v_exp_f32 v45, v45
    v_exp_f32 v46, v46
    v_exp_f32 v47, v47
    v_add_f32 v40, 1.0, v40
    v_add_f32 v41, 1.0, v41
    v_add_f32 v42, 1.0, v42
    v_add_f32 v43, 1.0, v43
    v_add_f32 v44, 1.0, v44
    v_add_f32 v45, 1.0, v45
    v_add_f32 v46, 1.0, v46
    v_add_f32 v47, 1.0, v47
    v_rcp_f32 v40, v40
    v_rcp_f32 v41, v41
    v_rcp_f32 v42, v42
    v_rcp_f32 v43, v43
    v_rcp_f32 v44, v44
    v_rcp_f32 v45, v45
    v_rcp_f32 v46, v46
    v_rcp_f32 v47, v47
    v_mul_f32 v40, v40, v48
    v_mul_f32 v41, v41, v49
    v_mul_f32 v42, v42, v50
    v_mul_f32 v43, v43, v51
    v_mul_f32 v44, v44, v52
    v_mul_f32 v45, v45, v53
    v_mul_f32 v46, v46, v54
    v_mul_f32 v47, v47, v55
    v_cvt_pk_bf16_f32 v4, v40, v41
    v_cvt_pk_bf16_f32 v5, v42, v43
    v_cvt_pk_bf16_f32 v6, v44, v45
    v_cvt_pk_bf16_f32 v7, v46, v47
    v_perm_b32 v24, v108, v104, s12
    v_perm_b32 v28, v108, v104, s13
    v_perm_b32 v25, v116, v112, s12
    v_perm_b32 v29, v116, v112, s13
    v_perm_b32 v26, v124, v120, s12
    v_perm_b32 v30, v124, v120, s13
    v_perm_b32 v27, v132, v128, s12
    v_perm_b32 v31, v132, v128, s13
    s_nop 0
    v_mfma_f32_16x16x32_bf16 v[40:43], v[4:7], v[24:27], 0
    v_mfma_f32_16x16x32_bf16 v[44:47], v[4:7], v[28:31], 0
    v_perm_b32 v32, v109, v105, s12
    v_perm_b32 v36, v109, v105, s13
    v_perm_b32 v33, v117, v113, s12
    v_perm_b32 v37, v117, v113, s13
    v_perm_b32 v34, v125, v121, s12
    v_perm_b32 v38, v125, v121, s13
    v_perm_b32 v35, v133, v129, s12
    v_perm_b32 v39, v133, v129, s13
    s_nop 0
    v_mfma_f32_16x16x32_bf16 v[48:51], v[4:7], v[32:35], 0
    v_mfma_f32_16x16x32_bf16 v[52:55], v[4:7], v[36:39], 0
    v_perm_b32 v24, v110, v106, s12
    v_perm_b32 v28, v110, v106, s13
    v_perm_b32 v25, v118, v114, s12
    v_perm_b32 v29, v118, v114, s13
    v_perm_b32 v26, v126, v122, s12
    v_perm_b32 v30, v126, v122, s13
    v_perm_b32 v27, v134, v130, s12
    v_perm_b32 v31, v134, v130, s13
    s_nop 0
    v_mfma_f32_16x16x32_bf16 v[56:59], v[4:7], v[24:27], 0
    v_mfma_f32_16x16x32_bf16 v[60:63], v[4:7], v[28:31], 0
    v_perm_b32 v32, v111, v107, s12
    v_perm_b32 v36, v111, v107, s13
    v_perm_b32 v33, v119, v115, s12
    v_perm_b32 v37, v119, v115, s13
    v_perm_b32 v34, v127, v123, s12
    v_perm_b32 v38, v127, v123, s13
    v_perm_b32 v35, v135, v131, s12
    v_perm_b32 v39, v135, v131, s13
    s_nop 0
    v_mfma_f32_16x16x32_bf16 v[64:67], v[4:7], v[32:35], 0
    v_mfma_f32_16x16x32_bf16 v[68:71], v[4:7], v[36:39], 0
    v_cndmask_b32 v8, v40, v56, s[14:15]
    v_cndmask_b32 v9, v44, v60, s[14:15]
    s_nop 4
    v_cndmask_b32 v10, v48, v64, s[14:15]
    v_cndmask_b32 v11, v52, v68, s[14:15]
    ds_write_b128 v16, v[8:11] offset:9216
    s_waitcnt vmcnt(0)
    v_lshlrev_b32 v40, 16, v72
    v_and_b32 v41, 0xffff0000, v72
    v_lshlrev_b32 v42, 16, v73
    v_and_b32 v43, 0xffff0000, v73
    v_lshlrev_b32 v44, 16, v74
    v_and_b32 v45, 0xffff0000, v74
    v_lshlrev_b32 v46, 16, v75
    v_and_b32 v47, 0xffff0000, v75
    v_lshlrev_b32 v48, 16, v76
    v_and_b32 v49, 0xffff0000, v76
    v_lshlrev_b32 v50, 16, v77
    v_and_b32 v51, 0xffff0000, v77
    v_lshlrev_b32 v52, 16, v78
    v_and_b32 v53, 0xffff0000, v78
    v_lshlrev_b32 v54, 16, v80
    v_and_b32 v55, 0xffff0000, v80
    v_lshlrev_b32 v56, 16, v81
    v_and_b32 v57, 0xffff0000, v81
    v_lshlrev_b32 v58, 16, v82
    v_and_b32 v59, 0xffff0000, v82
    v_lshlrev_b32 v60, 16, v83
    v_and_b32 v61, 0xffff0000, v83
    v_lshlrev_b32 v62, 16, v84
    v_and_b32 v63, 0xffff0000, v84
    v_lshlrev_b32 v64, 16, v85
    v_and_b32 v65, 0xffff0000, v85
    v_lshlrev_b32 v66, 16, v86
    v_and_b32 v67, 0xffff0000, v86
    v_lshlrev_b32 v68, 16, v88
    v_and_b32 v69, 0xffff0000, v88
    v_lshlrev_b32 v70, 16, v89
    v_and_b32 v71, 0xffff0000, v89
    v_lshlrev_b32 v72, 16, v90
    v_and_b32 v73, 0xffff0000, v90
    v_lshlrev_b32 v74, 16, v91
    v_and_b32 v75, 0xffff0000, v91
    v_lshlrev_b32 v76, 16, v92
    v_and_b32 v77, 0xffff0000, v92
    v_lshlrev_b32 v78, 16, v93
    v_and_b32 v79, 0xffff0000, v93
    v_lshlrev_b32 v80, 16, v94
    v_and_b32 v81, 0xffff0000, v94
    v_pk_mul_f32 v[82:83], v[54:55], v[68:69]
    v_pk_mul_f32 v[68:69], v[40:41], v[68:69]
    v_pk_mul_f32 v[84:85], v[56:57], v[70:71]
    v_pk_mul_f32 v[70:71], v[42:43], v[70:71]
    v_pk_mul_f32 v[86:87], v[58:59], v[72:73]
    v_pk_mul_f32 v[72:73], v[44:45], v[72:73]
    v_pk_mul_f32 v[88:89], v[60:61], v[74:75]
    v_pk_mul_f32 v[74:75], v[46:47], v[74:75]
    v_pk_mul_f32 v[90:91], v[62:63], v[76:77]
    v_pk_mul_f32 v[76:77], v[48:49], v[76:77]
    v_pk_mul_f32 v[92:93], v[64:65], v[78:79]
    v_pk_mul_f32 v[78:79], v[50:51], v[78:79]
    v_pk_mul_f32 v[94:95], v[66:67], v[80:81]
    v_pk_mul_f32 v[80:81], v[52:53], v[80:81]
    v_mov_b32 v96, 0xc0135761
    v_mov_b32 v97, 0xc0135761
    v_mov_b32 v98, 0xbdd2d3e8
    v_mov_b32 v99, 0xbdd2d3e8
    v_mov_b32 v100, 1.0
    v_mov_b32 v101, 1.0
    s_cmp_lg_u32 s67, 1
    s_cbranch_scc1 L_c2d
    s_bfe_u32 s4, s2, 0x30000
    s_mul_i32 s4, s4, 135168
    s_bfe_u32 s5, s2, 0x10003
    s_lshl_b32 s5, s5, 8
    s_add_u32 s4, s4, s5
    s_bfe_u32 s5, s2, 0x20004
    s_lshl_b32 s5, s5, 6
    s_add_u32 s4, s4, s5
    s_add_u32 s4, s4, 393216
    v_lshrrev_b32 v5, 5, v0
    v_mul_u32_u24 v5, 1081344, v5
    v_add_u32 v4, s4, v5
    v_bfe_u32 v5, v0, 3, 2
    v_mul_u32_u24 v5, 8448, v5
    v_add_u32 v4, v4, v5
    v_and_b32 v5, 1, v0
    v_lshl_add_u32 v4, v5, 9, v4
    v_bfe_u32 v5, v0, 1, 2
    v_lshl_add_u32 v4, v5, 4, v4
    buffer_load_dwordx4 v[104:107], v4, s[44:47], 0 offen offset:0 sc1
    s_mov_b32 s11, 32768
    buffer_load_dwordx4 v[108:111], v4, s[44:47], s11 offen offset:1024 sc1
    s_mov_b32 s11, 65536
    buffer_load_dwordx4 v[112:115], v4, s[44:47], s11 offen offset:2048 sc1
    s_mov_b32 s11, 98304
    buffer_load_dwordx4 v[116:119], v4, s[44:47], s11 offen offset:3072 sc1
    s_waitcnt vmcnt(3)
    v_xor_b32 v104, s56, v104
    v_xor_b32 v105, s57, v105
    v_xor_b32 v106, s58, v106
    v_xor_b32 v107, s59, v107
    v_or3_b32 v5, v104, v105, v106
    v_bitop3_b32 v5, v5, v107, v3 bitop3:0xa8
    v_cmp_ne_u32 s[86:87], 0, v5
    s_waitcnt vmcnt(2)
    v_xor_b32 v108, s56, v108
    v_xor_b32 v109, s57, v109
    v_xor_b32 v110, s58, v110
    v_xor_b32 v111, s59, v111
    v_or3_b32 v5, v108, v109, v110
    v_bitop3_b32 v5, v5, v111, v3 bitop3:0xa8
    v_cmp_ne_u32 s[88:89], 0, v5
    s_waitcnt vmcnt(1)
    v_xor_b32 v112, s56, v112
    v_xor_b32 v113, s57, v113
    v_xor_b32 v114, s58, v114
    v_xor_b32 v115, s59, v115
    v_or3_b32 v5, v112, v113, v114
    v_bitop3_b32 v5, v5, v115, v3 bitop3:0xa8
    v_cmp_ne_u32 s[90:91], 0, v5
    s_waitcnt vmcnt(0)
    v_xor_b32 v116, s56, v116
    v_xor_b32 v117, s57, v117
    v_xor_b32 v118, s58, v118
    v_xor_b32 v119, s59, v119
    v_or3_b32 v5, v116, v117, v118
    v_bitop3_b32 v5, v5, v119, v3 bitop3:0xa8
    v_cmp_ne_u32 s[92:93], 0, v5
    s_mov_b32 s10, 131072
Lpoll_3:
    s_or_b64 s[8:9], s[86:87], s[88:89]
    s_or_b64 s[8:9], s[8:9], s[90:91]
    s_or_b64 s[8:9], s[8:9], s[92:93]
    s_cbranch_scc0 Lpend_4
    s_sub_u32 s10, s10, 1
    s_cbranch_scc1 Lpend_4
    s_and_b32 s8, s10, 127
    s_cbranch_scc1 Lnet_5
    s_mov_b64 exec, -1
    buffer_wbl2 sc1
    s_waitcnt vmcnt(0)
    buffer_inv sc1
    s_waitcnt vmcnt(0)
Lnet_5:
    s_mov_b64 exec, s[86:87]
    s_cbranch_execz Lsk_6
    buffer_load_dwordx4 v[104:107], v4, s[44:47], 0 offen offset:0 sc1
Lsk_6:
    s_mov_b64 exec, s[88:89]
    s_cbranch_execz Lsk_7
    s_mov_b32 s11, 32768
    buffer_load_dwordx4 v[108:111], v4, s[44:47], s11 offen offset:1024 sc1
Lsk_7:
    s_mov_b64 exec, s[90:91]
    s_cbranch_execz Lsk_8
    s_mov_b32 s11, 65536
    buffer_load_dwordx4 v[112:115], v4, s[44:47], s11 offen offset:2048 sc1
Lsk_8:
    s_mov_b64 exec, s[92:93]
    s_cbranch_execz Lsk_9
    s_mov_b32 s11, 98304
    buffer_load_dwordx4 v[116:119], v4, s[44:47], s11 offen offset:3072 sc1
Lsk_9:
    s_waitcnt vmcnt(0)
    s_mov_b64 exec, s[86:87]
    s_cbranch_execz Lsk_10
    v_xor_b32 v104, s56, v104
    v_xor_b32 v105, s57, v105
    v_xor_b32 v106, s58, v106
    v_xor_b32 v107, s59, v107
    v_or3_b32 v5, v104, v105, v106
    v_bitop3_b32 v5, v5, v107, v3 bitop3:0xa8
    v_cmp_ne_u32 s[86:87], 0, v5
Lsk_10:
    s_mov_b64 exec, s[88:89]
    s_nop 2
    s_cbranch_execz Lsk_11
    v_xor_b32 v108, s56, v108
    v_xor_b32 v109, s57, v109
    v_xor_b32 v110, s58, v110
    v_xor_b32 v111, s59, v111
    v_or3_b32 v5, v108, v109, v110
    v_bitop3_b32 v5, v5, v111, v3 bitop3:0xa8
    v_cmp_ne_u32 s[88:89], 0, v5
Lsk_11:
    s_mov_b64 exec, s[90:91]
    s_nop 2
    s_cbranch_execz Lsk_12
    v_xor_b32 v112, s56, v112
    v_xor_b32 v113, s57, v113
    v_xor_b32 v114, s58, v114
    v_xor_b32 v115, s59, v115
    v_or3_b32 v5, v112, v113, v114
    v_bitop3_b32 v5, v5, v115, v3 bitop3:0xa8
    v_cmp_ne_u32 s[90:91], 0, v5
Lsk_12:
    s_mov_b64 exec, s[92:93]
    s_nop 2
    s_cbranch_execz Lsk_13
    v_xor_b32 v116, s56, v116
    v_xor_b32 v117, s57, v117
    v_xor_b32 v118, s58, v118
    v_xor_b32 v119, s59, v119
    v_or3_b32 v5, v116, v117, v118
    v_bitop3_b32 v5, v5, v119, v3 bitop3:0xa8
    v_cmp_ne_u32 s[92:93], 0, v5
Lsk_13:
    s_nop 3
    s_branch Lpoll_3
Lpend_4:
    s_mov_b64 exec, -1
    v_add_f32 v4, v104, v108
    v_add_f32 v5, v105, v109
    v_add_f32 v6, v106, v110
    v_add_f32 v7, v107, v111
    v_add_f32 v4, v4, v112
    v_add_f32 v5, v5, v113
    v_add_f32 v6, v6, v114
    v_add_f32 v7, v7, v115
    v_add_f32 v4, v4, v116
    v_add_f32 v5, v5, v117
    v_add_f32 v6, v6, v118
    v_add_f32 v7, v7, v119
    v_add_f32_dpp v4, v4, v4 row_ror:8 row_mask:0xf bank_mask:0xf
    v_add_f32_dpp v5, v5, v5 row_ror:8 row_mask:0xf bank_mask:0xf
    v_add_f32_dpp v6, v6, v6 row_ror:8 row_mask:0xf bank_mask:0xf
    v_add_f32_dpp v7, v7, v7 row_ror:8 row_mask:0xf bank_mask:0xf
    v_mov_b32 v8, v4
    v_mov_b32 v9, v5
    v_mov_b32 v10, v6
    v_mov_b32 v11, v7
    v_permlane16_swap_b32 v4, v8
    v_permlane16_swap_b32 v5, v9
    v_permlane16_swap_b32 v6, v10
    v_permlane16_swap_b32 v7, v11
    v_add_f32 v4, v4, v8
    v_add_f32 v5, v5, v9
    v_add_f32 v6, v6, v10
    v_add_f32 v7, v7, v11
    v_cvt_pk_bf16_f32 v8, v4, v5
    v_lshlrev_b32 v4, 16, v8
    v_and_b32 v5, 0xffff0000, v8
    v_cvt_pk_bf16_f32 v9, v6, v7
    v_lshlrev_b32 v6, 16, v9
    v_and_b32 v7, 0xffff0000, v9
    v_mov_b32 v8, v4
    v_mov_b32 v9, v5
    v_mov_b32 v10, v6
    v_mov_b32 v11, v7
    v_permlane32_swap_b32 v4, v8
    v_permlane32_swap_b32 v5, v9
    v_permlane32_swap_b32 v6, v10
    v_permlane32_swap_b32 v7, v11
    v_add_f32 v8, 1.0, v8
    v_add_f32 v9, 1.0, v9
    v_add_f32 v10, 1.0, v10
    v_add_f32 v11, 1.0, v11
    v_cvt_pk_bf16_f32 v13, v8, v9
    v_lshlrev_b32 v8, 16, v13
    v_and_b32 v9, 0xffff0000, v13
    v_cvt_pk_bf16_f32 v14, v10, v11
    v_lshlrev_b32 v10, 16, v14
    v_and_b32 v11, 0xffff0000, v14
    v_mul_f32 v8, v8, v20
    v_mul_f32 v9, v9, v21
    v_mul_f32 v10, v10, v22
    v_mul_f32 v11, v11, v23
    v_cvt_pk_bf16_f32 v13, v8, v9
    v_lshlrev_b32 v8, 16, v13
    v_and_b32 v9, 0xffff0000, v13
    v_cvt_pk_bf16_f32 v14, v10, v11
    v_lshlrev_b32 v10, 16, v14
    v_and_b32 v11, 0xffff0000, v14
    v_add_f32 v8, v4, v8
    v_add_f32 v9, v5, v9
    v_add_f32 v10, v6, v10
    v_add_f32 v11, v7, v11
    v_cvt_pk_bf16_f32 v13, v8, v9
    v_lshlrev_b32 v8, 16, v13
    v_and_b32 v9, 0xffff0000, v13
    v_cvt_pk_bf16_f32 v14, v10, v11
    v_lshlrev_b32 v10, 16, v14
    v_and_b32 v11, 0xffff0000, v14
    v_or_b32 v8, s56, v8
    v_or_b32 v9, s57, v9
    v_or_b32 v10, s58, v10
    v_or_b32 v11, s59, v11
    s_bfe_u32 s4, s2, 0x30000
    s_lshl_b32 s4, s4, 10
    s_bfe_u32 s5, s2, 0x10003
    s_lshl_b32 s5, s5, 9
    s_add_u32 s4, s4, s5
    s_bfe_u32 s5, s2, 0x20004
    s_lshl_b32 s5, s5, 7
    s_add_u32 s4, s4, s5
    s_add_u32 s4, s4, 81920
    v_lshl_add_u32 v4, v0, 4, s4
    s_mov_b64 exec, 0xff
    buffer_store_dwordx4 v[8:11], v4, s[44:47], 0 offen sc1
    s_mov_b64 exec, -1
L_c2d:
    s_mov_b32 s5, 20
    s_mov_b32 s63, 2856
    s_call_b64 s[68:69], L_tab
    s_bfe_u32 s4, s2, 0x30005
    s_lshl_b32 s4, s4, 10
    s_bfe_u32 s5, s3, 0x20000
    s_lshl_b32 s5, s5, 7
    s_add_u32 s4, s4, s5
    s_add_u32 s4, s4, 81920
    v_bfe_u32 v5, v0, 2, 1
    v_lshl_add_u32 v4, v5, 9, s4
    v_lshrrev_b32 v5, 4, v0
    v_lshl_add_u32 v4, v5, 5, v4
    v_and_b32 v5, 1, v0
    v_lshl_add_u32 v4, v5, 4, v4
    s_mov_b32 s10, 2621440
    v_mov_b32 v7, 0
Lspin_14:
    ds_read_b32 v6, v7 offset:2856
    s_waitcnt lgkmcnt(0)
    v_readfirstlane_b32 s11, v6
    s_nop 0
    s_cmp_ge_u32 s11, 8
    s_nop 1
    s_cbranch_scc1 Lspe_15
    s_sleep 2
    s_sub_u32 s10, s10, 1
    s_cbranch_scc0 Lspin_14
Lspe_15:
    buffer_load_dwordx4 v[104:107], v4, s[44:47], 0 offen offset:0 sc1
    s_waitcnt vmcnt(0)
    v_xor_b32 v104, s56, v104
    v_xor_b32 v105, s57, v105
    v_xor_b32 v106, s58, v106
    v_xor_b32 v107, s59, v107
    v_or3_b32 v5, v104, v105, v106
    v_bitop3_b32 v5, v5, v107, v3 bitop3:0xa8
    v_cmp_ne_u32 s[86:87], 0, v5
    s_mov_b32 s10, 131072
Lpoll_16:
    s_cmp_eq_u64 s[86:87], 0
    s_nop 1
    s_cbranch_scc1 Lpend_17
    s_sub_u32 s10, s10, 1
    s_cbranch_scc1 Lpend_17
    s_and_b32 s8, s10, 127
    s_cbranch_scc1 Lnet_18
    s_mov_b64 exec, -1
    buffer_wbl2 sc1
    s_waitcnt vmcnt(0)
    buffer_inv sc1
    s_waitcnt vmcnt(0)
Lnet_18:
    s_mov_b64 exec, s[86:87]
    buffer_load_dwordx4 v[104:107], v4, s[44:47], 0 offen offset:0 sc1
    s_waitcnt vmcnt(0)
    v_xor_b32 v104, s56, v104
    v_xor_b32 v105, s57, v105
    v_xor_b32 v106, s58, v106
    v_xor_b32 v107, s59, v107
    v_or3_b32 v5, v104, v105, v106
    v_bitop3_b32 v5, v5, v107, v3 bitop3:0xa8
    v_cmp_ne_u32 s[86:87], 0, v5
    s_nop 3
    s_branch Lpoll_16
Lpend_17:
    s_mov_b64 exec, -1
    v_perm_b32 v12, v105, v104, s13
    v_perm_b32 v13, v107, v106, s13
    s_nop 0
    v_mov_b32_dpp v4, v12 quad_perm:[0,0,2,2] row_mask:0xf bank_mask:0xf
    v_mov_b32_dpp v5, v13 quad_perm:[0,0,2,2] row_mask:0xf bank_mask:0xf
    v_mov_b32_dpp v6, v12 quad_perm:[1,1,3,3] row_mask:0xf bank_mask:0xf
    v_mov_b32_dpp v7, v13 quad_perm:[1,1,3,3] row_mask:0xf bank_mask:0xf
    v_perm_b32 v24, v140, v136, s12
    v_perm_b32 v28, v140, v136, s13
    v_perm_b32 v25, v148, v144, s12
    v_perm_b32 v29, v148, v144, s13
    v_perm_b32 v26, v156, v152, s12
    v_perm_b32 v30, v156, v152, s13
    v_perm_b32 v27, v164, v160, s12
    v_perm_b32 v31, v164, v160, s13
    s_nop 0
    v_mfma_f32_16x16x32_bf16 v[104:107], v[4:7], v[24:27], 0
    v_mfma_f32_16x16x32_bf16 v[108:111], v[4:7], v[28:31], 0
    v_perm_b32 v32, v141, v137, s12
    v_perm_b32 v36, v141, v137, s13
    v_perm_b32 v33, v149, v145, s12
    v_perm_b32 v37, v149, v145, s13
    v_perm_b32 v34, v157, v153, s12
    v_perm_b32 v38, v157, v153, s13
    v_perm_b32 v35, v165, v161, s12
    v_perm_b32 v39, v165, v161, s13
    s_nop 0
    v_mfma_f32_16x16x32_bf16 v[112:115], v[4:7], v[32:35], 0
    v_mfma_f32_16x16x32_bf16 v[116:119], v[4:7], v[36:39], 0
    v_perm_b32 v24, v142, v138, s12
    v_perm_b32 v28, v142, v138, s13
    v_perm_b32 v25, v150, v146, s12
    v_perm_b32 v29, v150, v146, s13
    v_perm_b32 v26, v158, v154, s12
    v_perm_b32 v30, v158, v154, s13
    v_perm_b32 v27, v166, v162, s12
    v_perm_b32 v31, v166, v162, s13
    s_nop 0
    v_mfma_f32_16x16x32_bf16 v[120:123], v[4:7], v[24:27], 0
    v_mfma_f32_16x16x32_bf16 v[124:127], v[4:7], v[28:31], 0
    v_perm_b32 v32, v143, v139, s12
    v_perm_b32 v36, v143, v139, s13
    v_perm_b32 v33, v151, v147, s12
    v_perm_b32 v37, v151, v147, s13
    v_perm_b32 v34, v159, v155, s12
    v_perm_b32 v38, v159, v155, s13
    v_perm_b32 v35, v167, v163, s12
    v_perm_b32 v39, v167, v163, s13
    s_nop 0
    v_mfma_f32_16x16x32_bf16 v[128:131], v[4:7], v[32:35], 0
    v_mfma_f32_16x16x32_bf16 v[132:135], v[4:7], v[36:39], 0
    s_bfe_u32 s4, s2, 0x80000
    s_mul_i32 s4, s4, 8448
    s_add_u32 s4, s4, 394240
    v_add_u32 v14, s4, v18
    v_cndmask_b32 v8, v104, v120, s[14:15]
    v_cndmask_b32 v9, v108, v124, s[14:15]
    s_nop 0
    v_cndmask_b32 v10, v112, v128, s[14:15]
    v_cndmask_b32 v11, v116, v132, s[14:15]
    ds_write_b128 v16, v[8:11] offset:3072
    v_mov_b32 v12, 0
    v_mov_b32 v13, 1
    s_waitcnt lgkmcnt(0)
    s_mov_b64 exec, 1
    ds_add_rtn_u32 v13, v12, v13 offset:2816
    s_mov_b64 exec, -1
    s_waitcnt lgkmcnt(0)
    v_readfirstlane_b32 s4, v13
    s_nop 0
    s_cmp_lg_u32 s4, 3
    s_nop 1
    s_cbranch_scc1 L_c3
    ds_read_b128 v[104:107], v18 offset:3072
    ds_read_b128 v[108:111], v18 offset:4096
    ds_read_b128 v[112:115], v18 offset:5120
    ds_read_b128 v[116:119], v18 offset:6144
    s_waitcnt lgkmcnt(0)
    v_add_f32 v4, v104, v108
    v_add_f32 v8, v112, v116
    v_add_f32 v5, v105, v109
    v_add_f32 v9, v113, v117
    v_add_f32 v6, v106, v110
    v_add_f32 v10, v114, v118
    v_add_f32 v7, v107, v111
    v_add_f32 v11, v115, v119
    v_add_f32 v4, v4, v8
    v_add_f32 v5, v5, v9
    v_add_f32 v6, v6, v10
    v_add_f32 v7, v7, v11
    v_add_u32 v8, 0x80, v4
    v_add_u32 v9, 0x80, v5
    v_add_u32 v10, 0x80, v6
    v_add_u32 v11, 0x80, v7
    v_bfi_b32 v8, v3, s56, v8
    v_bfi_b32 v9, v3, s57, v9
    v_bfi_b32 v10, v3, s58, v10
    v_bfi_b32 v11, v3, s59, v11
    buffer_store_dwordx4 v[8:11], v14, s[44:47], 0 offen
L_c3:
    s_add_u32 s5, s66, 3
    s_min_u32 s5, s5, 20
    s_mov_b32 s63, 2872
    s_call_b64 s[68:69], L_tab
    s_bfe_u32 s4, s2, 0x10007
    s_lshl_b32 s4, s4, 14
    s_bfe_u32 s5, s2, 0x30000
    s_lshl_b32 s5, s5, 11
    s_add_u32 s4, s4, s5
    s_bfe_u32 s5, s2, 0x40003
    s_lshl_b32 s5, s5, 7
    s_add_u32 s4, s4, s5
    v_lshl_add_u32 v17, v0, 4, s4
    s_cmp_lg_u32 s3, 2
    s_cbranch_scc1 L_r2
    s_bfe_u32 s4, s2, 0x30000
    s_mul_i32 s4, s4, 8448
    s_bfe_u32 s5, s2, 0x20005
    s_mul_i32 s5, s5, 67584
    s_add_u32 s4, s4, s5
    s_bfe_u32 s5, s2, 0x10007
    s_lshl_b32 s5, s5, 9
    s_add_u32 s4, s4, s5
    s_bfe_u32 s5, s2, 0x20003
    s_lshl_b32 s5, s5, 7
    s_add_u32 s4, s4, s5
    s_add_u32 s4, s4, 394240
    v_lshrrev_b32 v5, 3, v0
    v_mul_u32_u24 v5, 270336, v5
    v_add_u32 v4, s4, v5
    v_and_b32 v5, 7, v0
    v_lshl_add_u32 v4, v5, 4, v4
    buffer_load_dwordx4 v[104:107], v4, s[44:47], 0 offen offset:0 sc1
    s_waitcnt vmcnt(0)
    v_xor_b32 v104, s56, v104
    v_xor_b32 v105, s57, v105
    v_xor_b32 v106, s58, v106
    v_xor_b32 v107, s59, v107
    v_or3_b32 v5, v104, v105, v106
    v_bitop3_b32 v5, v5, v107, v3 bitop3:0xa8
    v_cmp_ne_u32 s[86:87], 0, v5
    s_mov_b32 s10, 131072
Lpoll_19:
    s_cmp_eq_u64 s[86:87], 0
    s_nop 1
    s_cbranch_scc1 Lpend_20
    s_sub_u32 s10, s10, 1
    s_cbranch_scc1 Lpend_20
    s_and_b32 s8, s10, 127
    s_cbranch_scc1 Lnet_21
    s_mov_b64 exec, -1
    buffer_wbl2 sc1
    s_waitcnt vmcnt(0)
    buffer_inv sc1
    s_waitcnt vmcnt(0)
Lnet_21:
    s_mov_b64 exec, s[86:87]
    buffer_load_dwordx4 v[104:107], v4, s[44:47], 0 offen offset:0 sc1
    s_waitcnt vmcnt(0)
    v_xor_b32 v104, s56, v104
    v_xor_b32 v105, s57, v105
    v_xor_b32 v106, s58, v106
    v_xor_b32 v107, s59, v107
    v_or3_b32 v5, v104, v105, v106
    v_bitop3_b32 v5, v5, v107, v3 bitop3:0xa8
    v_cmp_ne_u32 s[86:87], 0, v5
    s_nop 3
    s_branch Lpoll_19
Lpend_20:
    s_mov_b64 exec, -1
    v_add_f32_dpp v104, v104, v104 row_ror:8 row_mask:0xf bank_mask:0xf
    v_add_f32_dpp v105, v105, v105 row_ror:8 row_mask:0xf bank_mask:0xf
    v_add_f32_dpp v106, v106, v106 row_ror:8 row_mask:0xf bank_mask:0xf
    v_add_f32_dpp v107, v107, v107 row_ror:8 row_mask:0xf bank_mask:0xf
    v_mov_b32 v8, v104
    v_mov_b32 v9, v105
    v_mov_b32 v10, v106
    v_mov_b32 v11, v107
    v_permlane16_swap_b32 v104, v8
    v_permlane16_swap_b32 v105, v9
    v_permlane16_swap_b32 v106, v10
    v_permlane16_swap_b32 v107, v11
    v_add_f32 v104, v104, v8
    v_add_f32 v105, v105, v9
    v_add_f32 v106, v106, v10
    v_add_f32 v107, v107, v11
    v_mov_b32 v8, v104
    v_mov_b32 v9, v105
    v_mov_b32 v10, v106
    v_mov_b32 v11, v107
    v_permlane32_swap_b32 v104, v8
    v_permlane32_swap_b32 v105, v9
    v_permlane32_swap_b32 v106, v10
    v_permlane32_swap_b32 v107, v11
    v_add_f32 v104, v104, v8
    v_add_f32 v105, v105, v9
    v_add_f32 v106, v106, v10
    v_add_f32 v107, v107, v11
    v_cvt_pk_bf16_f32 v8, v104, v105
    v_lshlrev_b32 v104, 16, v8
    v_and_b32 v105, 0xffff0000, v8
    v_cvt_pk_bf16_f32 v9, v106, v107
    v_lshlrev_b32 v106, 16, v9
    v_and_b32 v107, 0xffff0000, v9
    v_or_b32 v8, s56, v104
    v_or_b32 v9, s57, v105
    v_or_b32 v10, s58, v106
    v_or_b32 v11, s59, v107
    s_mov_b32 s7, 131072
    s_mov_b64 exec, 0xff
    buffer_store_dwordx4 v[8:11], v17, s[44:47], s7 offen sc1
    s_mov_b64 exec, -1
L_r2:
    s_mov_b32 s5, 20
    s_mov_b32 s63, 2860
    s_call_b64 s[68:69], L_tab
    s_mov_b32 s10, 2621440
    v_mov_b32 v7, 0
Lspin_22:
    ds_read_b32 v6, v7 offset:2860
    s_waitcnt lgkmcnt(0)
    v_readfirstlane_b32 s11, v6
    s_nop 0
    s_cmp_ge_u32 s11, 8
    s_nop 1
    s_cbranch_scc1 Lspe_23
    s_sleep 2
    s_sub_u32 s10, s10, 1
    s_cbranch_scc0 Lspin_22
Lspe_23:
    s_bfe_u32 s4, s2, 0x30000
    s_lshl_b32 s4, s4, 12
    s_add_u32 s4, s4, 131072
    v_add_u32 v4, s4, v19
    buffer_load_dwordx4 v[104:107], v4, s[44:47], 0 offen offset:0 sc1
    s_waitcnt vmcnt(0)
    v_xor_b32 v104, s56, v104
    v_xor_b32 v105, s57, v105
    v_xor_b32 v106, s58, v106
    v_xor_b32 v107, s59, v107
    v_or3_b32 v5, v104, v105, v106
    v_bitop3_b32 v5, v5, v107, v3 bitop3:0xa8
    v_cmp_ne_u32 s[86:87], 0, v5
    s_mov_b32 s10, 131072
Lpoll_24:
    s_cmp_eq_u64 s[86:87], 0
    s_nop 1
    s_cbranch_scc1 Lpend_25
    s_sub_u32 s10, s10, 1
    s_cbranch_scc1 Lpend_25
    s_and_b32 s8, s10, 127
    s_cbranch_scc1 Lnet_26
    s_mov_b64 exec, -1
    buffer_wbl2 sc1
    s_waitcnt vmcnt(0)
    buffer_inv sc1
    s_waitcnt vmcnt(0)
Lnet_26:
    s_mov_b64 exec, s[86:87]
    buffer_load_dwordx4 v[104:107], v4, s[44:47], 0 offen offset:0 sc1
    s_waitcnt vmcnt(0)
    v_xor_b32 v104, s56, v104
    v_xor_b32 v105, s57, v105
    v_xor_b32 v106, s58, v106
    v_xor_b32 v107, s59, v107
    v_or3_b32 v5, v104, v105, v106
    v_bitop3_b32 v5, v5, v107, v3 bitop3:0xa8
    v_cmp_ne_u32 s[86:87], 0, v5
    s_nop 3
    s_branch Lpoll_24
Lpend_25:
    s_mov_b64 exec, -1
    v_perm_b32 v4, v105, v104, s13
    v_perm_b32 v5, v107, v106, s13
    v_lshrrev_b32 v6, 1, v19
    ds_write_b64 v6, v[4:5] offset:0
    v_mov_b32 v8, 0
    v_mov_b32 v9, 1
    s_waitcnt lgkmcnt(0)
    s_mov_b64 exec, 1
    ds_add_u32 v8, v9 offset:2820
    s_mov_b64 exec, -1
    s_mov_b32 s5, 20
    s_mov_b32 s63, 2872
    s_call_b64 s[68:69], L_tab
    v_mov_b32 v4, 0
    v_mov_b32 v5, 1
    s_waitcnt lgkmcnt(0)
    s_mov_b64 exec, 1
    ds_add_rtn_u32 v5, v4, v5 offset:2832
    s_mov_b64 exec, -1
    s_waitcnt lgkmcnt(0)
    v_readfirstlane_b32 s4, v5
    s_nop 0
    s_cmp_lg_u32 s4, 3
    s_nop 1
    s_cbranch_scc1 L_c3d
    s_mov_b64 exec, 31
    v_lshlrev_b32 v4, 8, v0
    ds_read_b128 v[40:43], v4 offset:7168
    ds_read_b128 v[44:47], v4 offset:7184
    ds_read_b128 v[48:51], v4 offset:7200
    ds_read_b128 v[52:55], v4 offset:7216
    ds_read_b128 v[56:59], v4 offset:7232
    ds_read_b128 v[60:63], v4 offset:7248
    ds_read_b128 v[64:67], v4 offset:7264
    ds_read_b128 v[68:71], v4 offset:7280
    ds_read_b128 v[72:75], v4 offset:7296
    ds_read_b128 v[76:79], v4 offset:7312
    ds_read_b128 v[80:83], v4 offset:7328
    ds_read_b128 v[84:87], v4 offset:7344
    ds_read_b128 v[88:91], v4 offset:7360
    ds_read_b128 v[92:95], v4 offset:7376
    ds_read_b128 v[96:99], v4 offset:7392
    ds_read_b128 v[100:103], v4 offset:7408
    s_mul_i32 s4, s2, 80
    s_add_u32 s4, s4, 98304
    v_add_u32 v12, s4, v18
    s_waitcnt lgkmcnt(0)
    v_add_f32 v4, v40, v41
    v_add_f32 v4, v4, v42
    v_add_f32 v4, v4, v43
    v_add_f32 v4, v4, v44
    v_add_f32 v4, v4, v45
    v_add_f32 v4, v4, v46
    v_add_f32 v4, v4, v47
    v_add_f32 v4, v4, v48
    v_add_f32 v4, v4, v49
    v_add_f32 v4, v4, v50
    v_add_f32 v4, v4, v51
    v_add_f32 v4, v4, v52
    v_add_f32 v4, v4, v53
    v_add_f32 v4, v4, v54
    v_add_f32 v4, v4, v55
    v_add_f32 v5, v56, v57
    v_add_f32 v5, v5, v58
    v_add_f32 v5, v5, v59
    v_add_f32 v5, v5, v60
    v_add_f32 v5, v5, v61
    v_add_f32 v5, v5, v62
    v_add_f32 v5, v5, v63
    v_add_f32 v5, v5, v64
    v_add_f32 v5, v5, v65
    v_add_f32 v5, v5, v66
    v_add_f32 v5, v5, v67
    v_add_f32 v5, v5, v68
    v_add_f32 v5, v5, v69
    v_add_f32 v5, v5, v70
    v_add_f32 v5, v5, v71
    v_add_f32 v6, v72, v73
    v_add_f32 v6, v6, v74
    v_add_f32 v6, v6, v75
    v_add_f32 v6, v6, v76
    v_add_f32 v6, v6, v77
    v_add_f32 v6, v6, v78
    v_add_f32 v6, v6, v79
    v_add_f32 v6, v6, v80
    v_add_f32 v6, v6, v81
    v_add_f32 v6, v6, v82
    v_add_f32 v6, v6, v83
    v_add_f32 v6, v6, v84
    v_add_f32 v6, v6, v85
    v_add_f32 v6, v6, v86
    v_add_f32 v6, v6, v87
    v_add_f32 v7, v88, v89
    v_add_f32 v7, v7, v90
    v_add_f32 v7, v7, v91
    v_add_f32 v7, v7, v92
    v_add_f32 v7, v7, v93
    v_add_f32 v7, v7, v94
    v_add_f32 v7, v7, v95
    v_add_f32 v7, v7, v96
    v_add_f32 v7, v7, v97
    v_add_f32 v7, v7, v98
    v_add_f32 v7, v7, v99
    v_add_f32 v7, v7, v100
    v_add_f32 v7, v7, v101
    v_add_f32 v7, v7, v102
    v_add_f32 v7, v7, v103
    v_add_u32 v8, 0x80, v4
    v_add_u32 v9, 0x80, v5
    v_add_u32 v10, 0x80, v6
    v_add_u32 v11, 0x80, v7
    v_bfi_b32 v8, v3, s56, v8
    v_bfi_b32 v9, v3, s57, v9
    v_bfi_b32 v10, v3, s58, v10
    v_bfi_b32 v11, v3, s59, v11
    buffer_store_dwordx4 v[8:11], v12, s[44:47], 0 offen sc1
    s_mov_b64 exec, -1
L_c3d:
    s_cmp_lg_u32 s3, 2
    s_cbranch_scc1 L_cpf
    s_getpc_b64 s[8:9]
L_pc:
    s_lshr_b32 s4, s2, 3
    s_and_b32 s4, s4, 15
    s_lshl_b32 s4, s4, 10
    s_min_u32 s4, s4, L_codeend-L_pc-1024
    v_add_u32 v4, s4, v18
    global_load_dwordx4 v[144:147], v4, s[8:9]
L_cpf:
    s_mov_b32 s52, s24
    s_mov_b32 s53, s25
    s_mov_b32 s54, 8388608
    s_mov_b32 s55, 0x20000
    s_bfe_u32 s4, s2, 0x30000
    s_lshl_b32 s4, s4, 20
    s_bfe_u32 s5, s2, 0x20003
    s_lshl_b32 s5, s5, 18
    s_add_u32 s4, s4, s5
    s_bfe_u32 s5, s3, 0x20000
    s_lshl_b32 s5, s5, 16
    s_add_u32 s4, s4, s5
    s_bfe_u32 s5, s2, 0x30005
    s_lshl_b32 s5, s5, 8
    s_add_u32 s4, s4, s5
    v_lshrrev_b32 v4, 4, v0
    v_lshl_add_u32 v33, v4, 14, s4
    v_and_b32 v4, 15, v0
    v_lshl_add_u32 v33, v4, 4, v33
    s_bfe_u32 s4, s2, 0x30000
    s_mul_i32 s4, s4, 270336
    s_bfe_u32 s5, s2, 0x50003
    s_mul_i32 s5, s5, 8448
    s_add_u32 s4, s4, s5
    s_bfe_u32 s5, s3, 0x20000
    s_lshl_b32 s5, s5, 10
    s_add_u32 s4, s4, s5
    s_add_u32 s4, s4, 397312
    v_lshl_add_u32 v27, v0, 4, s4
    s_bfe_u32 s4, s3, 0x20000
    s_lshl_b32 s4, s4, 6
    v_lshrrev_b32 v4, 5, v0
    v_lshl_add_u32 v28, v4, 5, s4
    s_bfe_u32 s4, s2, 0x30000
    s_mul_i32 s4, s4, 270336
    s_bfe_u32 s5, s2, 0x50003
    s_lshl_b32 s5, s5, 7
    s_add_u32 s4, s4, s5
    s_bfe_u32 s5, s3, 0x20000
    s_lshl_b32 s5, s5, 5
    s_add_u32 s4, s4, s5
    s_add_u32 s4, s4, 397312
    v_lshrrev_b32 v4, 1, v0
    v_mul_u32_u24 v4, 8448, v4
    v_add_u32 v31, s4, v4
    v_and_b32 v4, 1, v0
    v_lshl_add_u32 v31, v4, 4, v31
    s_bfe_u32 s4, s2, 0x20001
    s_lshl_b32 s4, s4, 12
    s_bfe_u32 s5, s2, 0x10000
    s_lshl_b32 s5, s5, 11
    s_add_u32 s4, s4, s5
    s_bfe_u32 s5, s2, 0x20003
    s_lshl_b32 s5, s5, 9
    s_add_u32 s4, s4, s5
    s_bfe_u32 s5, s3, 0x20000
    s_lshl_b32 s5, s5, 7
    s_add_u32 s4, s4, s5
    s_add_u32 s4, s4, 262144
    v_bfe_u32 v4, v0, 2, 1
    v_lshl_add_u32 v29, v4, 14, s4
    v_lshrrev_b32 v4, 4, v0
    v_lshl_add_u32 v29, v4, 5, v29
    v_and_b32 v4, 1, v0
    v_lshl_add_u32 v29, v4, 4, v29
    s_bfe_u32 s4, s2, 0x30000
    s_lshl_b32 s4, s4, 12
    s_bfe_u32 s5, s2, 0x50003
    s_lshl_b32 s5, s5, 7
    s_add_u32 s4, s4, s5
    s_bfe_u32 s5, s3, 0x20000
    s_lshl_b32 s5, s5, 5
    s_add_u32 s4, s4, s5
    s_add_u32 s4, s4, 262144
    v_and_b32 v4, 7, v0
    v_lshl_add_u32 v17, v4, 4, s4
    v_lshrrev_b32 v4, 5, v0
    v_lshl_add_u32 v17, v4, 3, v17
    s_bfe_u32 s4, s2, 0x30000
    s_mul_i32 s4, s4, 270336
    s_bfe_u32 s5, s2, 0x20003
    s_mul_i32 s5, s5, 67584
    s_add_u32 s4, s4, s5
    s_bfe_u32 s5, s2, 0x30005
    s_mul_i32 s5, s5, 8448
    s_add_u32 s4, s4, s5
    s_add_u32 s4, s4, 396288
    v_add_u32 v30, s4, v18
    s_bfe_u32 s4, s2, 0x10007
    s_mul_i32 s4, s4, 1081344
    s_bfe_u32 s5, s2, 0x40000
    s_mul_i32 s5, s5, 67584
    s_add_u32 s4, s4, s5
    s_bfe_u32 s5, s2, 0x30004
    s_mul_i32 s5, s5, 8448
    s_add_u32 s4, s4, s5
    s_add_u32 s4, s4, 395264
    v_add_u32 v32, s4, v18
    s_bfe_u32 s4, s2, 0x10002
    s_lshl_b32 s4, s4, 11
    s_bfe_u32 s5, s2, 0x50003
    s_lshl_b32 s5, s5, 6
    s_add_u32 s4, s4, s5
    v_and_b32 v4, 7, v0
    v_lshl_add_u32 v36, v4, 3, s4
    v_bfe_u32 v4, v0, 4, 1
    v_lshl_add_u32 v36, v4, 2, v36
    v_lshrrev_b32 v4, 5, v0
    v_lshl_add_u32 v36, v4, 1, v36
    s_bfe_u32 s4, s2, 0x10002
    s_lshl_b32 s4, s4, 12
    s_bfe_u32 s5, s2, 0x50003
    s_lshl_b32 s5, s5, 7
    s_add_u32 s4, s4, s5
    v_lshrrev_b32 v4, 5, v0
    v_lshl_add_u32 v26, v4, 4, s4
    v_and_b32 v4, 3, v0
    v_lshl_add_u32 v26, v4, 5, v26
    s_bfe_u32 s4, s2, 0x10002
    s_lshl_b32 s4, s4, 12
    v_lshrrev_b32 v4, 5, v0
    v_lshl_add_u32 v37, v4, 4, s4
    v_and_b32 v4, 31, v0
    v_lshl_add_u32 v37, v4, 7, v37
    s_bfe_u32 s4, s2, 0x30005
    s_mul_i32 s4, s4, 8448
    s_bfe_u32 s5, s2, 0x10002
    s_lshl_b32 s5, s5, 9
    s_add_u32 s4, s4, s5
    s_bfe_u32 s5, s2, 0x20003
    s_lshl_b32 s5, s5, 7
    s_add_u32 s4, s4, s5
    s_add_u32 s4, s4, 396288
    v_lshrrev_b32 v4, 3, v0
    v_mul_u32_u24 v4, 67584, v4
    v_add_u32 v38, s4, v4
    v_and_b32 v4, 7, v0
    v_lshl_add_u32 v38, v4, 4, v38
    s_bfe_u32 s4, s2, 0x30005
    s_mul_i32 s4, s4, 67584
    s_bfe_u32 s5, s2, 0x10002
    s_lshl_b32 s5, s5, 9
    s_add_u32 s4, s4, s5
    s_bfe_u32 s5, s2, 0x20003
    s_lshl_b32 s5, s5, 7
    s_add_u32 s4, s4, s5
    s_add_u32 s4, s4, 395264
    v_lshrrev_b32 v4, 3, v0
    v_mul_u32_u24 v4, 8448, v4
    v_add_u32 v34, s4, v4
    v_and_b32 v4, 7, v0
    v_lshl_add_u32 v34, v4, 4, v34
    s_cmp_lg_u32 s3, 1
    s_cbranch_scc1 L_c4
    global_load_ushort v24, v36, s[16:17]
    v_mov_b32 v7, 0
    global_load_ushort v25, v7, s[34:35]
L_c4:
    s_cmp_lg_u32 s3, 3
    s_cbranch_scc1 L_c5
    s_mov_b32 s10, 2621440
    v_mov_b32 v5, 0
Lspin_27:
    ds_read_b32 v4, v5 offset:2824
    s_waitcnt lgkmcnt(0)
    v_readfirstlane_b32 s11, v4
    s_nop 0
    s_cmp_ge_u32 s11, 8
    s_nop 1
    s_cbranch_scc1 Lspe_28
    s_sleep 4
    s_sub_u32 s10, s10, 1
    s_cbranch_scc0 Lspin_27
Lspe_28:
    v_lshlrev_b32 v4, 3, v0
    ds_read_b64 v[8:9], v4 offset:2048
    s_mov_b32 s7, 0x3fb8aa3b
    s_waitcnt lgkmcnt(0)
    v_mov_b32 v4, v8
    v_mov_b32 v39, v8
    s_nop 0
    v_max_f32_dpp v4, v4, v4 row_ror:8 row_mask:0xf bank_mask:0xf
    v_mov_b32 v6, v4
    s_nop 1
    v_permlane16_swap_b32 v4, v6
    v_max_f32 v4, v4, v6
    v_mov_b32 v6, v4
    s_nop 1
    v_permlane32_swap_b32 v4, v6
    v_max_f32 v4, v4, v6
    v_sub_f32 v5, v8, v4
    v_mul_f32 v5, s7, v5
    v_exp_f32 v5, v5
    s_nop 0
    v_mul_f32 v5, v5, v9
    s_nop 1
    v_add_f32_dpp v5, v5, v5 row_ror:8 row_mask:0xf bank_mask:0xf
    v_mov_b32 v6, v5
    s_nop 1
    v_permlane16_swap_b32 v5, v6
    v_add_f32 v5, v5, v6
    v_mov_b32 v6, v5
    s_nop 1
    v_permlane32_swap_b32 v5, v6
    v_add_f32 v5, v5, v6
    s_getreg_b32 s67, hwreg(HW_REG_XCC_ID, 0, 4)
    v_mov_b32 v6, s67
    v_mov_b32 v7, s60
    s_bfe_u32 s4, s2, 0x30000
    s_lshl_b32 s4, s4, 12
    s_bfe_u32 s5, s2, 0x50003
    s_lshl_b32 s5, s5, 7
    s_add_u32 s4, s4, s5
    s_add_u32 s4, s4, 32768
    v_lshl_add_u32 v12, v0, 4, s4
    s_mov_b64 exec, 0xff
    buffer_store_dwordx4 v[4:7], v12, s[44:47], 0 offen
    s_mov_b64 exec, -1
    s_bfe_u32 s4, s2, 0x30000
    s_lshl_b32 s4, s4, 12
    s_add_u32 s4, s4, 32768
    v_lshl_add_u32 v12, v0, 4, s4
    s_mov_b32 s10, 2621440
    v_mov_b32 v9, 0
Lspin_29:
    ds_read_b32 v8, v9 offset:2840
    s_waitcnt lgkmcnt(0)
    v_readfirstlane_b32 s11, v8
    s_nop 0
    s_cmp_ge_u32 s11, 8
    s_nop 1
    s_cbranch_scc1 Lspe_30
    s_sleep 4
    s_sub_u32 s10, s10, 1
    s_cbranch_scc0 Lspin_29
Lspe_30:
    buffer_load_dwordx4 v[104:107], v12, s[44:47], 0 offen offset:0 sc1
    buffer_load_dwordx4 v[108:111], v12, s[44:47], 0 offen offset:1024 sc1
    buffer_load_dwordx4 v[112:115], v12, s[44:47], 0 offen offset:2048 sc1
    buffer_load_dwordx4 v[116:119], v12, s[44:47], 0 offen offset:3072 sc1
    s_waitcnt vmcnt(3)
    v_cmp_ne_u32 s[86:87], s60, v107
    s_waitcnt vmcnt(2)
    v_cmp_ne_u32 s[88:89], s60, v111
    s_waitcnt vmcnt(1)
    v_cmp_ne_u32 s[90:91], s60, v115
    s_waitcnt vmcnt(0)
    v_cmp_ne_u32 s[92:93], s60, v119
    s_mov_b32 s10, 131072
Lpoll_31:
    s_or_b64 s[8:9], s[86:87], s[88:89]
    s_or_b64 s[8:9], s[8:9], s[90:91]
    s_or_b64 s[8:9], s[8:9], s[92:93]
    s_cbranch_scc0 Lpend_32
    s_sub_u32 s10, s10, 1
    s_cbranch_scc1 Lpend_32
    s_and_b32 s8, s10, 127
    s_cbranch_scc1 Lnet_33
    s_mov_b64 exec, -1
    buffer_wbl2 sc1
    s_waitcnt vmcnt(0)
    buffer_inv sc1
    s_waitcnt vmcnt(0)
Lnet_33:
    s_mov_b64 exec, s[86:87]
    s_cbranch_execz Lsk_34
    buffer_load_dwordx4 v[104:107], v12, s[44:47], 0 offen offset:0 sc1
Lsk_34:
    s_mov_b64 exec, s[88:89]
    s_cbranch_execz Lsk_35
    buffer_load_dwordx4 v[108:111], v12, s[44:47], 0 offen offset:1024 sc1
Lsk_35:
    s_mov_b64 exec, s[90:91]
    s_cbranch_execz Lsk_36
    buffer_load_dwordx4 v[112:115], v12, s[44:47], 0 offen offset:2048 sc1
Lsk_36:
    s_mov_b64 exec, s[92:93]
    s_cbranch_execz Lsk_37
    buffer_load_dwordx4 v[116:119], v12, s[44:47], 0 offen offset:3072 sc1
Lsk_37:
    s_waitcnt vmcnt(0)
    s_mov_b64 exec, s[86:87]
    s_cbranch_execz Lsk_38
    v_cmp_ne_u32 s[86:87], s60, v107
Lsk_38:
    s_mov_b64 exec, s[88:89]
    s_nop 2
    s_cbranch_execz Lsk_39
    v_cmp_ne_u32 s[88:89], s60, v111
Lsk_39:
    s_mov_b64 exec, s[90:91]
    s_nop 2
    s_cbranch_execz Lsk_40
    v_cmp_ne_u32 s[90:91], s60, v115
Lsk_40:
    s_mov_b64 exec, s[92:93]
    s_nop 2
    s_cbranch_execz Lsk_41
    v_cmp_ne_u32 s[92:93], s60, v119
Lsk_41:
    s_nop 3
    s_branch Lpoll_31
Lpend_32:
    s_mov_b64 exec, -1
    v_xor_b32 v106, s67, v106
    v_xor_b32 v110, s67, v110
    v_xor_b32 v114, s67, v114
    v_xor_b32 v118, s67, v118
    v_or3_b32 v4, v106, v110, v114
    v_or_b32 v4, v4, v118
    v_cmp_ne_u32 vcc, 0, v4
    s_nop 0
    s_or_b32 s4, vcc_lo, vcc_hi
    v_mov_b32 v4, s4
    v_mov_b32 v5, 0
    ds_write_b32 v5, v4 offset:2852
    v_max3_f32 v4, v104, v108, v112
    v_max_f32 v4, v4, v116
    s_nop 1
    v_max_f32_dpp v4, v4, v4 row_ror:8 row_mask:0xf bank_mask:0xf
    v_mov_b32 v6, v4
    s_nop 1
    v_permlane16_swap_b32 v4, v6
    v_max_f32 v4, v4, v6
    v_mov_b32 v6, v4
    s_nop 1
    v_permlane32_swap_b32 v4, v6
    v_max_f32 v4, v4, v6
    v_sub_f32 v8, v104, v4
    v_sub_f32 v9, v108, v4
    v_sub_f32 v10, v112, v4
    v_sub_f32 v11, v116, v4
    v_mul_f32 v8, s7, v8
    v_mul_f32 v9, s7, v9
    v_mul_f32 v10, s7, v10
    v_mul_f32 v11, s7, v11
    v_exp_f32 v8, v8
    v_exp_f32 v9, v9
    v_exp_f32 v10, v10
    v_exp_f32 v11, v11
    v_mul_f32 v5, v8, v105
    v_fmac_f32 v5, v9, v109
    v_fmac_f32 v5, v10, v113
    v_fmac_f32 v5, v11, v117
    s_nop 1
    v_add_f32_dpp v5, v5, v5 row_ror:8 row_mask:0xf bank_mask:0xf
    v_mov_b32 v6, v5
    s_nop 1
    v_permlane16_swap_b32 v5, v6
    v_add_f32 v5, v5, v6
    v_mov_b32 v6, v5
    s_nop 1
    v_permlane32_swap_b32 v5, v6
    v_add_f32 v5, v5, v6
    v_rcp_f32 v5, v5
    v_sub_f32 v6, v39, v4
    v_mul_f32 v6, s7, v6
    v_exp_f32 v6, v6
    s_nop 0
    v_mul_f32 v6, v6, v5
    v_and_b32 v7, 7, v0
    v_lshlrev_b32 v7, 5, v7
    v_lshrrev_b32 v8, 3, v0
    v_lshl_add_u32 v7, v8, 2, v7
    ds_write_b32 v7, v6 offset:2560
    v_mov_b32 v8, 0
    v_mov_b32 v9, 1
    s_waitcnt lgkmcnt(0)
    s_mov_b64 exec, 1
    ds_add_u32 v8, v9 offset:2868
    s_mov_b64 exec, -1
L_c5:
    s_mov_b32 s10, 2621440
    v_mov_b32 v5, 0
Lspin_42:
    ds_read_b32 v4, v5 offset:2828
    s_waitcnt lgkmcnt(0)
    v_readfirstlane_b32 s11, v4
    s_nop 0
    s_cmp_ge_u32 s11, 8
    s_nop 1
    s_cbranch_scc1 Lspe_43
    s_sleep 2
    s_sub_u32 s10, s10, 1
    s_cbranch_scc0 Lspin_42
Lspe_43:
    s_cmp_lg_u32 s3, 2
    s_cbranch_scc1 L_pre1
    buffer_load_dwordx4 v[136:139], v31, s[44:47], 0 offen offset:0 sc1
L_pre1:
    s_cmp_lg_u32 s3, 1
    s_cbranch_scc1 L_pre2
    s_and_b32 s4, s2, 3
    s_cbranch_scc1 L_pre2
    s_mov_b32 s11, 73728
    buffer_load_dwordx4 v[140:143], v37, s[44:47], s11 offen offset:0 sc1
    s_mov_b32 s11, 65536
    buffer_load_dwordx4 v[144:147], v37, s[44:47], s11 offen offset:0 sc1
L_pre2:
    s_bfe_u32 s4, s3, 0x20000
    s_lshl_b32 s4, s4, 5
    v_and_b32 v4, 1, v0
    v_lshl_add_u32 v39, v4, 4, s4
    v_lshrrev_b32 v4, 5, v0
    v_lshl_add_u32 v39, v4, 3, v39
    s_bfe_u32 s4, s2, 0x30000
    s_lshl_b32 s4, s4, 12
    s_bfe_u32 s5, s2, 0x50003
    s_lshl_b32 s5, s5, 7
    s_add_u32 s4, s4, s5
    s_add_u32 s4, s4, 262144
    v_lshl_add_u32 v17, v0, 4, s4
    s_mov_b32 s10, 2621440
    v_mov_b32 v5, 0
Lspin_44:
    ds_read_b32 v4, v5 offset:2836
    s_waitcnt lgkmcnt(0)
    v_readfirstlane_b32 s11, v4
    s_nop 0
    s_cmp_ge_u32 s11, 8
    s_nop 1
    s_cbranch_scc1 Lspe_45
    s_sleep 2
    s_sub_u32 s10, s10, 1
    s_cbranch_scc0 Lspin_44
Lspe_45:
    buffer_load_dwordx4 v[40:43], v33, s[52:55], 0 offen nt
    s_mov_b32 s11, 2048
    buffer_load_dwordx4 v[44:47], v33, s[52:55], s11 offen nt
    s_mov_b32 s11, 4096
    buffer_load_dwordx4 v[48:51], v33, s[52:55], s11 offen nt
    s_mov_b32 s11, 6144
    buffer_load_dwordx4 v[52:55], v33, s[52:55], s11 offen nt
    s_mov_b32 s11, 8192
    buffer_load_dwordx4 v[56:59], v33, s[52:55], s11 offen nt
    s_mov_b32 s11, 10240
    buffer_load_dwordx4 v[60:63], v33, s[52:55], s11 offen nt
    s_mov_b32 s11, 12288
    buffer_load_dwordx4 v[64:67], v33, s[52:55], s11 offen nt
    s_mov_b32 s11, 14336
    buffer_load_dwordx4 v[68:71], v33, s[52:55], s11 offen nt
    s_bfe_u32 s4, s3, 0x20000
    s_lshl_b32 s4, s4, 10
    s_add_u32 s4, s4, 33792
    v_lshrrev_b32 v1, 5, v0
    v_lshl_add_u32 v2, v1, 9, s4
    v_bfe_u32 v1, v0, 1, 4
    v_lshl_add_u32 v2, v1, 4, v2
    v_and_b32 v1, 1, v0
    v_mul_u32_u24 v1, 384, v1
    v_xor_b32 v2, v2, v1
    v_add_u32 v1, 57344, v2
    s_mov_b32 s10, 2621440
    v_mov_b32 v13, 0
Lspin_46:
    ds_read_b32 v12, v13 offset:2868
    s_waitcnt lgkmcnt(0)
    v_readfirstlane_b32 s11, v12
    s_nop 0
    s_cmp_ge_u32 s11, 1
    s_nop 1
    s_cbranch_scc1 Lspe_47
    s_sleep 1
    s_sub_u32 s10, s10, 1
    s_cbranch_scc0 Lspin_46
Lspe_47:
    ds_read_b32 v35, v13 offset:2852
    ds_read_b128 v[4:7], v28 offset:2560
    ds_read_b128 v[8:11], v28 offset:2576
    s_waitcnt lgkmcnt(0)
    v_readfirstlane_b32 s67, v35
    s_barrier
    ds_read_b128 v[104:107], v2 offset:0
    ds_read_b128 v[108:111], v2 offset:14336
    ds_read_b128 v[112:115], v2 offset:28672
    ds_read_b128 v[116:119], v2 offset:43008
    ds_read_b128 v[120:123], v1 offset:0
    ds_read_b128 v[124:127], v1 offset:14336
    ds_read_b128 v[128:131], v1 offset:28672
    ds_read_b128 v[132:135], v1 offset:43008
    s_waitcnt lgkmcnt(7)
    v_pk_mul_f32 v[12:13], v[104:105], v[4:5] op_sel_hi:[1,0]
    v_pk_mul_f32 v[14:15], v[106:107], v[4:5] op_sel_hi:[1,0]
    s_waitcnt lgkmcnt(6)
    v_pk_fma_f32 v[12:13], v[108:109], v[4:5], v[12:13] op_sel:[0,1,0] op_sel_hi:[1,1,1]
    v_pk_fma_f32 v[14:15], v[110:111], v[4:5], v[14:15] op_sel:[0,1,0] op_sel_hi:[1,1,1]
    s_waitcnt lgkmcnt(5)
    v_pk_fma_f32 v[12:13], v[112:113], v[6:7], v[12:13] op_sel:[0,0,0] op_sel_hi:[1,0,1]
    v_pk_fma_f32 v[14:15], v[114:115], v[6:7], v[14:15] op_sel:[0,0,0] op_sel_hi:[1,0,1]
    s_waitcnt lgkmcnt(4)
    v_pk_fma_f32 v[12:13], v[116:117], v[6:7], v[12:13] op_sel:[0,1,0] op_sel_hi:[1,1,1]
    v_pk_fma_f32 v[14:15], v[118:119], v[6:7], v[14:15] op_sel:[0,1,0] op_sel_hi:[1,1,1]
    s_waitcnt lgkmcnt(3)
    v_pk_fma_f32 v[12:13], v[120:121], v[8:9], v[12:13] op_sel:[0,0,0] op_sel_hi:[1,0,1]
    v_pk_fma_f32 v[14:15], v[122:123], v[8:9], v[14:15] op_sel:[0,0,0] op_sel_hi:[1,0,1]
    s_waitcnt lgkmcnt(2)
    v_pk_fma_f32 v[12:13], v[124:125], v[8:9], v[12:13] op_sel:[0,1,0] op_sel_hi:[1,1,1]
    v_pk_fma_f32 v[14:15], v[126:127], v[8:9], v[14:15] op_sel:[0,1,0] op_sel_hi:[1,1,1]
    s_waitcnt lgkmcnt(1)
    v_pk_fma_f32 v[12:13], v[128:129], v[10:11], v[12:13] op_sel:[0,0,0] op_sel_hi:[1,0,1]
    v_pk_fma_f32 v[14:15], v[130:131], v[10:11], v[14:15] op_sel:[0,0,0] op_sel_hi:[1,0,1]
    s_waitcnt lgkmcnt(0)
    v_pk_fma_f32 v[12:13], v[132:133], v[10:11], v[12:13] op_sel:[0,1,0] op_sel_hi:[1,1,1]
    v_pk_fma_f32 v[14:15], v[134:135], v[10:11], v[14:15] op_sel:[0,1,0] op_sel_hi:[1,1,1]
    v_bfi_b32 v4, v3, s56, v12
    v_bfi_b32 v5, v3, s57, v13
    v_bfi_b32 v6, v3, s58, v14
    v_bfi_b32 v7, v3, s59, v15
    s_cmp_lg_u32 s67, 0
    s_cbranch_scc1 Lst_48
    buffer_store_dwordx4 v[4:7], v27, s[44:47], 0 offen
Lst_49:
    v_mov_b32 v9, s60
    v_mov_b32 v10, 0
    v_mov_b32 v11, 1
    s_mov_b32 s88, 0
    s_mov_b32 s10, 131072
Lsp_50:
    buffer_load_dwordx4 v[136:139], v31, s[44:47], s88 offen offset:0 sc1
Lspr_52:
    s_sub_u32 s10, s10, 1
    s_and_b32 s8, s10, 127
    s_cbranch_scc0 Lspx_53
Lspy_54:
    s_waitcnt vmcnt(0)
    v_xor_b32 v136, s56, v136
    v_xor_b32 v137, s57, v137
    v_xor_b32 v138, s58, v138
    v_xor_b32 v139, s59, v139
    v_or_b32 v12, v136, v137
    v_or3_b32 v12, v12, v138, v139
    v_and_b32 v12, 0xff, v12
    v_cmp_ne_u32 vcc, 0, v12
    s_cbranch_vccnz Lsp_50
Lspe_51:
    v_permlane32_swap_b32 v136, v138
    v_permlane32_swap_b32 v137, v139
    v_add_f32 v136, v136, v138
    v_add_f32 v137, v137, v139
    s_nop 1
    v_permlane16_swap_b32 v136, v137
    v_add_f32 v136, v136, v137
    s_nop 1
    v_add_f32_dpp v136, v136, v136 row_ror:2 row_mask:0xf bank_mask:0xf
    s_nop 1
    v_add_f32_dpp v136, v136, v136 row_ror:4 row_mask:0xf bank_mask:0xf
    s_nop 1
    v_add_f32_dpp v136, v136, v136 row_ror:8 row_mask:0xf bank_mask:0xf
    v_mov_b32 v137, v136
    s_nop 1
    v_permlane16_swap_b32 v136, v137
    v_cvt_pk_bf16_f32 v8, v136, v137
    s_mov_b32 exec_lo, 3
    s_mov_b32 exec_hi, 3
    ds_write_b64 v39, v[8:9] offset:2880
    s_mov_b64 exec, 1
    ds_add_rtn_u32 v11, v10, v11 offset:2864
    s_mov_b64 exec, 0xff
    ds_read_b128 v[4:7], v18 offset:2880
    s_waitcnt lgkmcnt(0)
    v_readfirstlane_b32 s4, v11
    s_nop 0
    s_cmp_lg_u32 s4, 3
    s_nop 1
    s_cbranch_scc1 L_o1
    buffer_store_dwordx4 v[4:7], v17, s[44:47], 0 offen sc1
L_o1:
    s_mov_b64 exec, -1
    s_cmp_lg_u32 s3, 0
    s_cbranch_scc1 L_pre3
    s_mov_b32 s10, 2621440
    v_mov_b32 v5, 0
Lspin_55:
    ds_read_b32 v4, v5 offset:2832
    s_waitcnt lgkmcnt(0)
    v_readfirstlane_b32 s11, v4
    s_nop 0
    s_cmp_ge_u32 s11, 4
    s_nop 1
    s_cbranch_scc1 Lspe_56
    s_sleep 1
    s_sub_u32 s10, s10, 1
    s_cbranch_scc0 Lspin_55
Lspe_56:
    ds_read_b128 v[104:107], v18 offset:9216
    ds_read_b128 v[108:111], v18 offset:10240
    ds_read_b128 v[112:115], v18 offset:11264
    ds_read_b128 v[116:119], v18 offset:12288
    s_waitcnt lgkmcnt(0)
    v_add_f32 v4, v104, v108
    v_add_f32 v8, v112, v116
    v_add_f32 v5, v105, v109
    v_add_f32 v9, v113, v117
    v_add_f32 v6, v106, v110
    v_add_f32 v10, v114, v118
    v_add_f32 v7, v107, v111
    v_add_f32 v11, v115, v119
    v_add_f32 v4, v4, v8
    v_add_f32 v5, v5, v9
    v_add_f32 v6, v6, v10
    v_add_f32 v7, v7, v11
    v_bfi_b32 v8, v3, s56, v4
    v_bfi_b32 v9, v3, s57, v5
    v_bfi_b32 v10, v3, s58, v6
    v_bfi_b32 v11, v3, s59, v7
    buffer_store_dwordx4 v[8:11], v32, s[44:47], 0 offen sc1
L_pre3:
    v_perm_b32 v72, v44, v40, s12
    v_perm_b32 v76, v44, v40, s13
    v_perm_b32 v73, v52, v48, s12
    v_perm_b32 v77, v52, v48, s13
    v_perm_b32 v74, v60, v56, s12
    v_perm_b32 v78, v60, v56, s13
    v_perm_b32 v75, v68, v64, s12
    v_perm_b32 v79, v68, v64, s13
    v_perm_b32 v80, v45, v41, s12
    v_perm_b32 v84, v45, v41, s13
    v_perm_b32 v81, v53, v49, s12
    v_perm_b32 v85, v53, v49, s13
    v_perm_b32 v82, v61, v57, s12
    v_perm_b32 v86, v61, v57, s13
    v_perm_b32 v83, v69, v65, s12
    v_perm_b32 v87, v69, v65, s13
    v_perm_b32 v88, v46, v42, s12
    v_perm_b32 v92, v46, v42, s13
    v_perm_b32 v89, v54, v50, s12
    v_perm_b32 v93, v54, v50, s13
    v_perm_b32 v90, v62, v58, s12
    v_perm_b32 v94, v62, v58, s13
    v_perm_b32 v91, v70, v66, s12
    v_perm_b32 v95, v70, v66, s13
    v_perm_b32 v96, v47, v43, s12
    v_perm_b32 v100, v47, v43, s13
    v_perm_b32 v97, v55, v51, s12
    v_perm_b32 v101, v55, v51, s13
    v_perm_b32 v98, v63, v59, s12
    v_perm_b32 v102, v63, v59, s13
    v_perm_b32 v99, v71, v67, s12
    v_perm_b32 v103, v71, v67, s13
    s_mov_b32 s88, 0
    s_mov_b32 s10, 131072
Lsp_57:
    buffer_load_dwordx4 v[104:107], v29, s[44:47], s88 offen offset:0 sc1
Lspr_59:
    s_sub_u32 s10, s10, 1
    s_and_b32 s8, s10, 127
    s_cbranch_scc0 Lspx_60
Lspy_61:
    s_waitcnt vmcnt(0)
    v_xor_b32 v12, s60, v105
    v_bitop3_b32 v12, v12, v107, s60 bitop3:0xf6
    v_cmp_ne_u32 vcc, 0, v12
    s_cbranch_vccnz Lsp_57
Lspe_58:
    v_mov_b32_dpp v4, v104 quad_perm:[0,0,2,2] row_mask:0xf bank_mask:0xf
    v_mov_b32_dpp v5, v106 quad_perm:[0,0,2,2] row_mask:0xf bank_mask:0xf
    v_mov_b32_dpp v6, v104 quad_perm:[1,1,3,3] row_mask:0xf bank_mask:0xf
    v_mov_b32_dpp v7, v106 quad_perm:[1,1,3,3] row_mask:0xf bank_mask:0xf
    s_nop 1
    v_mfma_f32_16x16x32_bf16 v[40:43], v[4:7], v[72:75], 0
    v_mfma_f32_16x16x32_bf16 v[44:47], v[4:7], v[76:79], 0
    v_mfma_f32_16x16x32_bf16 v[48:51], v[4:7], v[80:83], 0
    v_mfma_f32_16x16x32_bf16 v[52:55], v[4:7], v[84:87], 0
    v_mfma_f32_16x16x32_bf16 v[56:59], v[4:7], v[88:91], 0
    v_mfma_f32_16x16x32_bf16 v[60:63], v[4:7], v[92:95], 0
    v_mfma_f32_16x16x32_bf16 v[64:67], v[4:7], v[96:99], 0
    v_mfma_f32_16x16x32_bf16 v[68:71], v[4:7], v[100:103], 0
    s_nop 4
    v_cndmask_b32 v8, v40, v56, s[14:15]
    v_cndmask_b32 v9, v44, v60, s[14:15]
    v_cndmask_b32 v10, v48, v64, s[14:15]
    v_cndmask_b32 v11, v52, v68, s[14:15]
    ds_write_b128 v16, v[8:11] offset:3072
    s_waitcnt lgkmcnt(0)
    s_barrier
    s_cmp_lg_u32 s3, 0
    s_cbranch_scc1 L_c6
    ds_read_b128 v[104:107], v18 offset:3072
    ds_read_b128 v[108:111], v18 offset:4096
    ds_read_b128 v[112:115], v18 offset:5120
    ds_read_b128 v[116:119], v18 offset:6144
    s_waitcnt lgkmcnt(0)
    v_add_f32 v4, v104, v108
    v_add_f32 v8, v112, v116
    v_add_f32 v5, v105, v109
    v_add_f32 v9, v113, v117
    v_add_f32 v6, v106, v110
    v_add_f32 v10, v114, v118
    v_add_f32 v7, v107, v111
    v_add_f32 v11, v115, v119
    v_add_f32 v4, v4, v8
    v_add_f32 v5, v5, v9
    v_add_f32 v6, v6, v10
    v_add_f32 v7, v7, v11
    v_bfi_b32 v8, v3, s56, v4
    v_bfi_b32 v9, v3, s57, v5
    v_bfi_b32 v10, v3, s58, v6
    v_bfi_b32 v11, v3, s59, v7
    buffer_store_dwordx4 v[8:11], v30, s[44:47], 0 offen sc1
L_c6:
    s_and_b32 s4, s2, 3
    s_cbranch_scc1 L_pl1
    s_sub_u32 s4, s3, 1
    s_cmp_lt_u32 s4, 2
    s_cbranch_scc1 L_pl1
    s_and_b32 s4, s3, 1
    s_mul_i32 s4, s4, 10240
    v_add_u32 v4, s4, v18
    v_add_u32 v6, 98304, v4
    s_mov_b32 s88, 0
    s_mov_b32 s89, 0
    s_mov_b32 s90, 0
    s_mov_b32 s91, 0
    s_mov_b32 s92, 4096
    s_mov_b32 s93, 4096
    s_mov_b32 s94, 4096
    s_mov_b32 s95, 4096
    s_mov_b32 s96, 8192
    s_mov_b32 s97, 8192
    s_mov_b32 s10, 131072
Lsp_62:
    buffer_load_dwordx4 v[104:107], v6, s[44:47], s88 offen offset:0 sc1
    buffer_load_dwordx4 v[108:111], v6, s[44:47], s89 offen offset:1024 sc1
    buffer_load_dwordx4 v[112:115], v6, s[44:47], s90 offen offset:2048 sc1
    buffer_load_dwordx4 v[116:119], v6, s[44:47], s91 offen offset:3072 sc1
    buffer_load_dwordx4 v[120:123], v6, s[44:47], s92 offen offset:0 sc1
    buffer_load_dwordx4 v[124:127], v6, s[44:47], s93 offen offset:1024 sc1
    buffer_load_dwordx4 v[128:131], v6, s[44:47], s94 offen offset:2048 sc1
    buffer_load_dwordx4 v[132:135], v6, s[44:47], s95 offen offset:3072 sc1
    buffer_load_dwordx4 v[136:139], v6, s[44:47], s96 offen offset:0 sc1
    buffer_load_dwordx4 v[140:143], v6, s[44:47], s97 offen offset:1024 sc1
Lspr_64:
    s_sub_u32 s10, s10, 1
    s_and_b32 s8, s10, 127
    s_cbranch_scc0 Lspx_65
Lspy_66:
    s_waitcnt vmcnt(9)
    v_xor_b32 v104, s56, v104
    v_xor_b32 v105, s57, v105
    v_xor_b32 v106, s58, v106
    v_xor_b32 v107, s59, v107
    v_or_b32 v5, v104, v105
    v_or3_b32 v5, v5, v106, v107
    s_waitcnt vmcnt(8)
    v_xor_b32 v108, s56, v108
    v_xor_b32 v109, s57, v109
    v_xor_b32 v110, s58, v110
    v_xor_b32 v111, s59, v111
    v_or3_b32 v5, v5, v108, v109
    v_or3_b32 v5, v5, v110, v111
    s_waitcnt vmcnt(7)
    v_xor_b32 v112, s56, v112
    v_xor_b32 v113, s57, v113
    v_xor_b32 v114, s58, v114
    v_xor_b32 v115, s59, v115
    v_or3_b32 v5, v5, v112, v113
    v_or3_b32 v5, v5, v114, v115
    s_waitcnt vmcnt(6)
    v_xor_b32 v116, s56, v116
    v_xor_b32 v117, s57, v117
    v_xor_b32 v118, s58, v118
    v_xor_b32 v119, s59, v119
    v_or3_b32 v5, v5, v116, v117
    v_or3_b32 v5, v5, v118, v119
    s_waitcnt vmcnt(5)
    v_xor_b32 v120, s56, v120
    v_xor_b32 v121, s57, v121
    v_xor_b32 v122, s58, v122
    v_xor_b32 v123, s59, v123
    v_or3_b32 v5, v5, v120, v121
    v_or3_b32 v5, v5, v122, v123
    s_waitcnt vmcnt(4)
    v_xor_b32 v124, s56, v124
    v_xor_b32 v125, s57, v125
    v_xor_b32 v126, s58, v126
    v_xor_b32 v127, s59, v127
    v_or3_b32 v5, v5, v124, v125
    v_or3_b32 v5, v5, v126, v127
    s_waitcnt vmcnt(3)
    v_xor_b32 v128, s56, v128
    v_xor_b32 v129, s57, v129
    v_xor_b32 v130, s58, v130
    v_xor_b32 v131, s59, v131
    v_or3_b32 v5, v5, v128, v129
    v_or3_b32 v5, v5, v130, v131
    s_waitcnt vmcnt(2)
    v_xor_b32 v132, s56, v132
    v_xor_b32 v133, s57, v133
    v_xor_b32 v134, s58, v134
    v_xor_b32 v135, s59, v135
    v_or3_b32 v5, v5, v132, v133
    v_or3_b32 v5, v5, v134, v135
    s_waitcnt vmcnt(1)
    v_xor_b32 v136, s56, v136
    v_xor_b32 v137, s57, v137
    v_xor_b32 v138, s58, v138
    v_xor_b32 v139, s59, v139
    v_or3_b32 v5, v5, v136, v137
    v_or3_b32 v5, v5, v138, v139
    s_waitcnt vmcnt(0)
    v_xor_b32 v140, s56, v140
    v_xor_b32 v141, s57, v141
    v_xor_b32 v142, s58, v142
    v_xor_b32 v143, s59, v143
    v_or3_b32 v5, v5, v140, v141
    v_or3_b32 v5, v5, v142, v143
    v_and_b32 v5, 0xff, v5
    v_cmp_ne_u32 vcc, 0, v5
    s_cbranch_vccnz Lsp_62
Lspe_63:
    ds_write_b128 v4, v[104:107] offset:13312
    ds_write_b128 v4, v[108:111] offset:14336
    ds_write_b128 v4, v[112:115] offset:15360
    ds_write_b128 v4, v[116:119] offset:16384
    ds_write_b128 v4, v[120:123] offset:17408
    ds_write_b128 v4, v[124:127] offset:18432
    ds_write_b128 v4, v[128:131] offset:19456
    ds_write_b128 v4, v[132:135] offset:20480
    ds_write_b128 v4, v[136:139] offset:21504
    ds_write_b128 v4, v[140:143] offset:22528
    v_mov_b32 v8, 0
    v_mov_b32 v9, 1
    s_waitcnt lgkmcnt(0)
    s_mov_b64 exec, 1
    ds_add_u32 v8, v9 offset:2844
    s_mov_b64 exec, -1
    v_mov_b32 v8, 0
    v_mov_b32 v9, 1
    s_waitcnt lgkmcnt(0)
    s_mov_b64 exec, 1
    ds_add_u32 v8, v9 offset:2844
    s_mov_b64 exec, -1
L_pl1:
    s_and_b32 s4, s2, 3
    s_cbranch_scc1 L_c7
    s_cmp_eq_u32 s3, 1
    s_cbranch_scc1 L_fin
    s_cmp_lg_u32 s3, 2
    s_cbranch_scc1 L_c7
    s_mov_b32 s88, 0
    s_mov_b32 s89, 540672
    s_mov_b32 s90, 1081344
    s_mov_b32 s91, 1622016
    s_mov_b32 s10, 131072
Lsp_67:
    buffer_load_dwordx4 v[104:107], v34, s[44:47], s88 offen offset:0 sc1
    buffer_load_dwordx4 v[108:111], v34, s[44:47], s89 offen offset:0 sc1
    buffer_load_dwordx4 v[112:115], v34, s[44:47], s90 offen offset:0 sc1
    buffer_load_dwordx4 v[116:119], v34, s[44:47], s91 offen offset:0 sc1
Lspr_69:
    s_sub_u32 s10, s10, 1
    s_and_b32 s8, s10, 127
    s_cbranch_scc0 Lspx_70
Lspy_71:
    s_waitcnt vmcnt(3)
    v_xor_b32 v104, s56, v104
    v_xor_b32 v105, s57, v105
    v_xor_b32 v106, s58, v106
    v_xor_b32 v107, s59, v107
    v_or_b32 v5, v104, v105
    v_or3_b32 v5, v5, v106, v107
    s_waitcnt vmcnt(2)
    v_xor_b32 v108, s56, v108
    v_xor_b32 v109, s57, v109
    v_xor_b32 v110, s58, v110
    v_xor_b32 v111, s59, v111
    v_or3_b32 v5, v5, v108, v109
    v_or3_b32 v5, v5, v110, v111
    s_waitcnt vmcnt(1)
    v_xor_b32 v112, s56, v112
    v_xor_b32 v113, s57, v113
    v_xor_b32 v114, s58, v114
    v_xor_b32 v115, s59, v115
    v_or3_b32 v5, v5, v112, v113
    v_or3_b32 v5, v5, v114, v115
    s_waitcnt vmcnt(0)
    v_xor_b32 v116, s56, v116
    v_xor_b32 v117, s57, v117
    v_xor_b32 v118, s58, v118
    v_xor_b32 v119, s59, v119
    v_or3_b32 v5, v5, v116, v117
    v_or3_b32 v5, v5, v118, v119
    v_and_b32 v5, 0xff, v5
    v_cmp_ne_u32 vcc, 0, v5
    s_cbranch_vccnz Lsp_67
Lspe_68:
    v_permlane32_swap_b32 v104, v105
    v_permlane32_swap_b32 v106, v107
    v_permlane32_swap_b32 v108, v109
    v_permlane32_swap_b32 v110, v111
    v_permlane32_swap_b32 v112, v113
    v_permlane32_swap_b32 v114, v115
    v_permlane32_swap_b32 v116, v117
    v_permlane32_swap_b32 v118, v119
    v_add_f32 v104, v104, v105
    v_add_f32 v106, v106, v107
    v_add_f32 v108, v108, v109
    v_add_f32 v110, v110, v111
    v_add_f32 v112, v112, v113
    v_add_f32 v114, v114, v115
    v_add_f32 v116, v116, v117
    v_add_f32 v118, v118, v119
    v_permlane16_swap_b32 v104, v106
    v_permlane16_swap_b32 v108, v110
    v_permlane16_swap_b32 v112, v114
    v_permlane16_swap_b32 v116, v118
    v_add_f32 v104, v104, v106
    v_add_f32 v108, v108, v110
    v_add_f32 v112, v112, v114
    v_add_f32 v116, v116, v118
    v_add_f32_dpp v20, v104, v104 row_ror:8 row_mask:0xf bank_mask:0xf
    v_add_f32_dpp v21, v108, v108 row_ror:8 row_mask:0xf bank_mask:0xf
    v_add_f32_dpp v22, v112, v112 row_ror:8 row_mask:0xf bank_mask:0xf
    v_add_f32_dpp v23, v116, v116 row_ror:8 row_mask:0xf bank_mask:0xf
    v_cvt_pk_bf16_f32 v4, v20, v21
    v_lshlrev_b32 v20, 16, v4
    v_and_b32 v21, 0xffff0000, v4
    v_cvt_pk_bf16_f32 v5, v22, v23
    v_lshlrev_b32 v22, 16, v5
    v_and_b32 v23, 0xffff0000, v5
    v_add_f32 v22, 1.0, v22
    v_cvt_pk_bf16_f32 v22, v22, v22
    v_and_b32 v22, 0xffff0000, v22
    ds_write_b128 v18, v[20:23] offset:9216
    v_mov_b32 v12, 0
    v_mov_b32 v13, 1
    s_waitcnt lgkmcnt(0)
    s_mov_b64 exec, 1
    ds_add_u32 v12, v13 offset:2848
    s_mov_b64 exec, -1
    v_mov_b32 v4, v22
    v_mul_f32 v5, v22, v22
    v_mul_f32 v6, v22, v21
    v_mov_b32 v7, v21
    v_mul_f32 v8, v21, v21
    v_mov_b32 v9, 0
    v_permlane32_swap_b32 v4, v7
    v_permlane32_swap_b32 v5, v8
    v_permlane32_swap_b32 v6, v9
    v_add_f32 v4, v4, v7
    v_add_f32 v5, v5, v8
    v_add_f32 v6, v6, v9
    v_mov_b32 v7, s60
    v_add_f32_dpp v4, v4, v4 quad_perm:[1,0,3,2] row_mask:0xf bank_mask:0xf
    v_add_f32_dpp v5, v5, v5 quad_perm:[1,0,3,2] row_mask:0xf bank_mask:0xf
    v_add_f32_dpp v6, v6, v6 quad_perm:[1,0,3,2] row_mask:0xf bank_mask:0xf
    v_add_f32_dpp v4, v4, v4 quad_perm:[2,3,0,1] row_mask:0xf bank_mask:0xf
    v_add_f32_dpp v5, v5, v5 quad_perm:[2,3,0,1] row_mask:0xf bank_mask:0xf
    v_add_f32_dpp v6, v6, v6 quad_perm:[2,3,0,1] row_mask:0xf bank_mask:0xf
    v_add_f32_dpp v4, v4, v4 row_half_mirror row_mask:0xf bank_mask:0xf
    v_add_f32_dpp v5, v5, v5 row_half_mirror row_mask:0xf bank_mask:0xf
    v_add_f32_dpp v6, v6, v6 row_half_mirror row_mask:0xf bank_mask:0xf
    v_add_f32_dpp v4, v4, v4 row_bcast:15 row_mask:0xa bank_mask:0xf
    v_add_f32_dpp v5, v5, v5 row_bcast:15 row_mask:0xa bank_mask:0xf
    v_add_f32_dpp v6, v6, v6 row_bcast:15 row_mask:0xa bank_mask:0xf
    s_mov_b32 s7, 65536
    s_mov_b32 exec_lo, 0xf0000
    s_mov_b32 exec_hi, 0xf0000
    s_cmp_lg_u32 s67, 0
    s_cbranch_scc1 Lst_72
    buffer_store_dwordx4 v[4:7], v26, s[44:47], s7 offen
Lst_73:
    s_mov_b64 exec, -1
    s_mov_b32 s88, 65536
    s_mov_b32 s10, 131072
Lsp_74:
    buffer_load_dwordx4 v[104:107], v37, s[44:47], s88 offen offset:0 sc1
Lspr_76:
    s_sub_u32 s10, s10, 1
    s_and_b32 s8, s10, 127
    s_cbranch_scc0 Lspx_77
Lspy_78:
    s_waitcnt vmcnt(0)
    v_xor_b32 v12, s60, v107
    v_cmp_ne_u32 vcc, 0, v12
    s_cbranch_vccnz Lsp_74
Lspe_75:
    v_add_f32_dpp v104, v104, v104 quad_perm:[1,0,3,2] row_mask:0xf bank_mask:0xf
    v_add_f32_dpp v105, v105, v105 quad_perm:[1,0,3,2] row_mask:0xf bank_mask:0xf
    v_add_f32_dpp v106, v106, v106 quad_perm:[1,0,3,2] row_mask:0xf bank_mask:0xf
    v_add_f32_dpp v104, v104, v104 quad_perm:[2,3,0,1] row_mask:0xf bank_mask:0xf
    v_add_f32_dpp v105, v105, v105 quad_perm:[2,3,0,1] row_mask:0xf bank_mask:0xf
    v_add_f32_dpp v106, v106, v106 quad_perm:[2,3,0,1] row_mask:0xf bank_mask:0xf
    v_add_f32_dpp v104, v104, v104 row_half_mirror row_mask:0xf bank_mask:0xf
    v_add_f32_dpp v105, v105, v105 row_half_mirror row_mask:0xf bank_mask:0xf
    v_add_f32_dpp v106, v106, v106 row_half_mirror row_mask:0xf bank_mask:0xf
    v_add_f32_dpp v104, v104, v104 row_mirror row_mask:0xf bank_mask:0xf
    v_add_f32_dpp v105, v105, v105 row_mirror row_mask:0xf bank_mask:0xf
    v_add_f32_dpp v106, v106, v106 row_mirror row_mask:0xf bank_mask:0xf
    v_mov_b32 v108, v104
    v_mov_b32 v109, v105
    v_mov_b32 v110, v106
    v_permlane16_swap_b32 v104, v108
    v_permlane16_swap_b32 v105, v109
    v_permlane16_swap_b32 v106, v110
    v_add_f32 v104, v104, v108
    v_add_f32 v105, v105, v109
    v_add_f32 v106, v106, v110
    v_mul_f32 v48, 0x3a800000, v104
    v_mul_f32 v51, 0x3a800000, v104
    v_mul_f32 v49, 0x3a800000, v105
    v_mul_f32 v52, 0x3a800000, v105
    v_mul_f32 v50, 0x3a800000, v106
    v_mul_f32 v53, 0x3a800000, v106
    v_permlane32_swap_b32 v48, v51
    v_permlane32_swap_b32 v49, v52
    v_permlane32_swap_b32 v50, v53
    v_mov_b32 v4, 0
    s_mov_b64 exec, 1
    ds_write_b128 v4, v[48:51] offset:10240
    ds_write_b32 v4, v52 offset:10256
    s_mov_b64 exec, -1
    s_mov_b32 s10, 2621440
    v_mov_b32 v13, 0
Lspin_79:
    ds_read_b32 v12, v13 offset:2844
    s_waitcnt lgkmcnt(0)
    v_readfirstlane_b32 s11, v12
    s_nop 0
    s_cmp_ge_u32 s11, 3
    s_nop 1
    s_cbranch_scc1 Lspe_80
    s_sleep 1
    s_sub_u32 s10, s10, 1
    s_cbranch_scc0 Lspin_79
Lspe_80:
    v_mov_b32 v12, 0
    v_mov_b32 v13, 1
    s_waitcnt lgkmcnt(0)
    s_mov_b64 exec, 1
    ds_add_u32 v12, v13 offset:2848
    s_mov_b64 exec, -1
L_c7:
    s_endpgm
L_fin:
    v_lshlrev_b32 v24, 16, v24
    v_lshlrev_b32 v25, 16, v25
    s_mov_b32 s10, 2621440
    v_mov_b32 v13, 0
Lspin_81:
    ds_read_b32 v12, v13 offset:2848
    s_waitcnt lgkmcnt(0)
    v_readfirstlane_b32 s11, v12
    s_nop 0
    s_cmp_ge_u32 s11, 1
    s_nop 1
    s_cbranch_scc1 Lspe_82
    s_sub_u32 s10, s10, 1
    s_cbranch_scc0 Lspin_81
Lspe_82:
    ds_read_b128 v[20:23], v18 offset:9216
    s_mov_b32 s88, 0
    s_mov_b32 s89, 540672
    s_mov_b32 s90, 1081344
    s_mov_b32 s91, 1622016
    s_mov_b32 s10, 131072
Lsp_83:
    buffer_load_dwordx4 v[104:107], v38, s[44:47], s88 offen offset:0 sc1
    buffer_load_dwordx4 v[108:111], v38, s[44:47], s89 offen offset:0 sc1
    buffer_load_dwordx4 v[112:115], v38, s[44:47], s90 offen offset:0 sc1
    buffer_load_dwordx4 v[116:119], v38, s[44:47], s91 offen offset:0 sc1
Lspr_85:
    s_sub_u32 s10, s10, 1
    s_and_b32 s8, s10, 127
    s_cbranch_scc0 Lspx_86
Lspy_87:
    s_waitcnt vmcnt(3)
    v_xor_b32 v104, s56, v104
    v_xor_b32 v105, s57, v105
    v_xor_b32 v106, s58, v106
    v_xor_b32 v107, s59, v107
    v_or_b32 v12, v104, v105
    v_or3_b32 v12, v12, v106, v107
    s_waitcnt vmcnt(2)
    v_xor_b32 v108, s56, v108
    v_xor_b32 v109, s57, v109
    v_xor_b32 v110, s58, v110
    v_xor_b32 v111, s59, v111
    v_or3_b32 v12, v12, v108, v109
    v_or3_b32 v12, v12, v110, v111
    s_waitcnt vmcnt(1)
    v_xor_b32 v112, s56, v112
    v_xor_b32 v113, s57, v113
    v_xor_b32 v114, s58, v114
    v_xor_b32 v115, s59, v115
    v_or3_b32 v12, v12, v112, v113
    v_or3_b32 v12, v12, v114, v115
    s_waitcnt vmcnt(0)
    v_xor_b32 v116, s56, v116
    v_xor_b32 v117, s57, v117
    v_xor_b32 v118, s58, v118
    v_xor_b32 v119, s59, v119
    v_or3_b32 v12, v12, v116, v117
    v_or3_b32 v12, v12, v118, v119
    v_and_b32 v12, 0xff, v12
    v_cmp_ne_u32 vcc, 0, v12
    s_cbranch_vccnz Lsp_83
Lspe_84:
    v_add_f32 v4, v104, v108
    v_add_f32 v8, v112, v116
    v_add_f32 v5, v105, v109
    v_add_f32 v9, v113, v117
    v_add_f32 v6, v106, v110
    v_add_f32 v10, v114, v118
    v_add_f32 v7, v107, v111
    v_add_f32 v11, v115, v119
    v_add_f32 v4, v4, v8
    v_add_f32 v5, v5, v9
    v_add_f32 v6, v6, v10
    v_add_f32 v7, v7, v11
    v_permlane32_swap_b32 v4, v5
    s_nop 0
    v_permlane32_swap_b32 v6, v7
    v_add_f32 v4, v4, v5
    v_add_f32 v6, v6, v7
    s_nop 1
    v_permlane16_swap_b32 v4, v6
    v_add_f32 v4, v4, v6
    s_nop 1
    v_add_f32_dpp v4, v4, v4 row_ror:8 row_mask:0xf bank_mask:0xf
    s_waitcnt lgkmcnt(0)
    v_fmac_f32 v24, v4, v20
    v_mov_b32 v4, v24
    v_mul_f32 v5, v24, v24
    v_mul_f32 v6, v24, v22
    v_mul_f32 v7, v6, v6
    v_mul_f32 v8, v6, v22
    v_mul_f32 v9, v6, v21
    v_permlane32_swap_b32 v4, v7
    v_permlane32_swap_b32 v5, v8
    v_permlane32_swap_b32 v6, v9
    v_add_f32 v4, v4, v7
    v_add_f32 v5, v5, v8
    v_add_f32 v6, v6, v9
    v_mov_b32 v7, s60
    v_add_f32_dpp v4, v4, v4 quad_perm:[1,0,3,2] row_mask:0xf bank_mask:0xf
    v_add_f32_dpp v5, v5, v5 quad_perm:[1,0,3,2] row_mask:0xf bank_mask:0xf
    v_add_f32_dpp v6, v6, v6 quad_perm:[1,0,3,2] row_mask:0xf bank_mask:0xf
    v_add_f32_dpp v4, v4, v4 quad_perm:[2,3,0,1] row_mask:0xf bank_mask:0xf
    v_add_f32_dpp v5, v5, v5 quad_perm:[2,3,0,1] row_mask:0xf bank_mask:0xf
    v_add_f32_dpp v6, v6, v6 quad_perm:[2,3,0,1] row_mask:0xf bank_mask:0xf
    v_add_f32_dpp v4, v4, v4 row_half_mirror row_mask:0xf bank_mask:0xf
    v_add_f32_dpp v5, v5, v5 row_half_mirror row_mask:0xf bank_mask:0xf
    v_add_f32_dpp v6, v6, v6 row_half_mirror row_mask:0xf bank_mask:0xf
    v_add_f32_dpp v4, v4, v4 row_bcast:15 row_mask:0xa bank_mask:0xf
    v_add_f32_dpp v5, v5, v5 row_bcast:15 row_mask:0xa bank_mask:0xf
    v_add_f32_dpp v6, v6, v6 row_bcast:15 row_mask:0xa bank_mask:0xf
    s_mov_b32 s7, 73728
    s_mov_b32 exec_lo, 0xf0000
    s_mov_b32 exec_hi, 0xf0000
    s_cmp_lg_u32 s67, 0
    s_cbranch_scc1 Lst_88
    buffer_store_dwordx4 v[4:7], v26, s[44:47], s7 offen
Lst_89:
    s_mov_b64 exec, -1
    s_mov_b32 s88, 73728
    s_mov_b32 s10, 131072
    buffer_load_dwordx4 v[104:107], v37, s[44:47], s88 offen offset:0 sc1
    s_mov_b32 s10, 2621440
    v_mov_b32 v13, 0
Lspin_93:
    ds_read_b32 v12, v13 offset:2848
    s_waitcnt lgkmcnt(0)
    v_readfirstlane_b32 s11, v12
    s_nop 0
    s_cmp_ge_u32 s11, 2
    s_nop 1
    s_cbranch_scc1 Lspe_94
    s_sub_u32 s10, s10, 1
    s_cbranch_scc0 Lspin_93
Lspe_94:
    s_mov_b32 s10, 131072
    ds_read_b128 v[48:51], v13 offset:10240
    ds_read_b32 v52, v13 offset:10256
    s_branch Lspr_92
Lsp_90:
    buffer_load_dwordx4 v[104:107], v37, s[44:47], s88 offen offset:0 sc1
Lspr_92:
    s_sub_u32 s10, s10, 1
    s_and_b32 s8, s10, 127
    s_cbranch_scc0 Lspx_95
Lspy_96:
    s_waitcnt vmcnt(0)
    v_xor_b32 v12, s60, v107
    v_cmp_ne_u32 vcc, 0, v12
    s_cbranch_vccnz Lsp_90
Lspe_91:
    v_add_f32_dpp v104, v104, v104 quad_perm:[1,0,3,2] row_mask:0xf bank_mask:0xf
    v_add_f32_dpp v105, v105, v105 quad_perm:[1,0,3,2] row_mask:0xf bank_mask:0xf
    v_add_f32_dpp v106, v106, v106 quad_perm:[1,0,3,2] row_mask:0xf bank_mask:0xf
    v_add_f32_dpp v104, v104, v104 quad_perm:[2,3,0,1] row_mask:0xf bank_mask:0xf
    v_add_f32_dpp v105, v105, v105 quad_perm:[2,3,0,1] row_mask:0xf bank_mask:0xf
    v_add_f32_dpp v106, v106, v106 quad_perm:[2,3,0,1] row_mask:0xf bank_mask:0xf
    v_add_f32_dpp v104, v104, v104 row_half_mirror row_mask:0xf bank_mask:0xf
    v_add_f32_dpp v105, v105, v105 row_half_mirror row_mask:0xf bank_mask:0xf
    v_add_f32_dpp v106, v106, v106 row_half_mirror row_mask:0xf bank_mask:0xf
    v_add_f32_dpp v104, v104, v104 row_mirror row_mask:0xf bank_mask:0xf
    v_add_f32_dpp v105, v105, v105 row_mirror row_mask:0xf bank_mask:0xf
    v_add_f32_dpp v106, v106, v106 row_mirror row_mask:0xf bank_mask:0xf
    v_mov_b32 v108, v104
    v_mov_b32 v109, v105
    v_mov_b32 v110, v106
    v_permlane16_swap_b32 v104, v108
    v_permlane16_swap_b32 v105, v109
    v_permlane16_swap_b32 v106, v110
    v_add_f32 v104, v104, v108
    v_add_f32 v105, v105, v109
    v_add_f32 v106, v106, v110
    v_mul_f32 v40, 0x3a800000, v104
    v_mul_f32 v43, 0x3a800000, v104
    v_mul_f32 v41, 0x3a800000, v105
    v_mul_f32 v44, 0x3a800000, v105
    v_mul_f32 v42, 0x3a800000, v106
    v_mul_f32 v45, 0x3a800000, v106
    v_permlane32_swap_b32 v40, v43
    v_permlane32_swap_b32 v41, v44
    v_permlane32_swap_b32 v42, v45
    s_waitcnt lgkmcnt(0)
    v_fma_f32 v5, -v40, v40, v41
    v_fma_f32 v42, -v40, v48, v42
    v_max_f32 v5, 0, v5
    v_mul_f32 v10, v40, v49
    v_add_f32 v5, 0x3727c5ac, v5
    v_fma_f32 v45, -v40, v50, v45
    v_rsq_f32 v5, v5
    v_fma_f32 v10, -2.0, v44, v10
    v_sub_f32 v12, v24, v40
    v_fma_f32 v43, v40, v10, v43
    v_add_f32 v45, v45, v45
    v_mul_f32 v12, v12, v22
    v_fma_f32 v8, v5, v42, v51
    v_fma_f32 v43, v43, v5, v45
    v_fma_f32 v12, v12, v5, v21
    v_fma_f32 v9, v43, v5, v52
    v_fma_f32 v9, -v8, v8, v9
    v_sub_f32 v12, v12, v8
    v_max_f32 v9, 0, v9
    v_add_f32 v9, 0x3727c5ac, v9
    v_rsq_f32 v9, v9
    v_fmac_f32 v24, v25, v23
    v_mul_f32 v12, v12, v9
    v_cvt_pk_bf16_f32 v12, v12, v12
    v_and_b32 v12, 0xffff0000, v12
    v_bfe_u32 v13, v12, 16, 15
    v_subrev_u32 v13, 14208, v13
    v_lshrrev_b32 v14, 31, v12
    v_cmp_lt_u32 vcc, 2559, v13
    v_min_u32 v13, 2559, v13
    v_mul_u32_u24 v14, 2560, v14
    v_add_lshl_u32 v13, v13, v14, 2
    ds_read_b32 v15, v13 offset:13312
    s_cbranch_vccnz L_fb0
L_nofb:
    s_waitcnt lgkmcnt(0)
    v_fma_f32 v15, v15, v23, v24
    v_cvt_pk_bf16_f32 v15, v15, v15
    s_mov_b32 exec_lo, 0x00ff00ff
    s_mov_b32 exec_hi, 0x00ff00ff
    global_store_short v36, v15, s[40:41]
    s_cmp_lg_u32 s2, 0
    s_cbranch_scc1 L_f2
    v_mov_b32 v4, 0
    v_mov_b32 v5, s60
    s_mov_b64 exec, 1
    buffer_store_dword v5, v4, s[44:47], 0 offen
L_f2:
L_end:
    s_endpgm
Lst_48:
    buffer_store_dwordx4 v[4:7], v27, s[44:47], 0 offen sc1
    s_nop 0
    s_branch Lst_49
Lst_72:
    buffer_store_dwordx4 v[4:7], v26, s[44:47], s7 offen sc1
    s_nop 0
    s_branch Lst_73
Lst_88:
    buffer_store_dwordx4 v[4:7], v26, s[44:47], s7 offen sc1
    s_nop 0
    s_branch Lst_89
Lspx_53:
    s_cmp_eq_u32 s10, 0
    s_cbranch_scc1 Lspx_53e
    buffer_wbl2 sc1
    s_waitcnt vmcnt(0)
    buffer_inv sc1
    s_waitcnt vmcnt(0)
    s_branch Lspy_54
Lspx_53e:
    s_waitcnt vmcnt(0)
    s_branch Lspe_51
Lspx_60:
    s_cmp_eq_u32 s10, 0
    s_cbranch_scc1 Lspx_60e
    s_branch Lspy_61
Lspx_60e:
    s_waitcnt vmcnt(0)
    s_branch Lspe_58
Lspx_65:
    s_cmp_eq_u32 s10, 0
    s_cbranch_scc1 Lspx_65e
    s_branch Lspy_66
Lspx_65e:
    s_waitcnt vmcnt(0)
    s_branch Lspe_63
Lspx_70:
    s_cmp_eq_u32 s10, 0
    s_cbranch_scc1 Lspx_70e
    s_branch Lspy_71
Lspx_70e:
    s_waitcnt vmcnt(0)
    s_branch Lspe_68
Lspx_77:
    s_cmp_eq_u32 s10, 0
    s_cbranch_scc1 Lspx_77e
    s_branch Lspy_78
Lspx_77e:
    s_waitcnt vmcnt(0)
    s_branch Lspe_75
Lspx_86:
    s_cmp_eq_u32 s10, 0
    s_cbranch_scc1 Lspx_86e
    s_branch Lspy_87
Lspx_86e:
    s_waitcnt vmcnt(0)
    s_branch Lspe_84
Lspx_95:
    s_cmp_eq_u32 s10, 0
    s_cbranch_scc1 Lspx_95e
    s_branch Lspy_96
Lspx_95e:
    s_waitcnt vmcnt(0)
    s_branch Lspe_91
L_fb0:
    s_mov_b64 s[66:67], vcc
    s_waitcnt lgkmcnt(0)
    v_mov_b32 v96, 0xc0135761
    v_mov_b32 v97, 0xc0135761
    v_mov_b32 v98, 0xbdd2d3e8
    v_mov_b32 v99, 0xbdd2d3e8
    v_mov_b32 v100, 1.0
    v_mov_b32 v101, 1.0
L_fb:
    s_ff1_i32_b64 s4, s[66:67]
    v_readlane_b32 s64, v12, s4
    s_mov_b32 s6, 0
    v_mov_b32 v13, 0
    s_mov_b32 s65, s64
L_fb2:
    s_mul_i32 s4, s6, 1792
    v_mul_u32_u24 v4, 28, v0
    v_add_u32 v4, s4, v4
    global_load_dwordx4 v[72:75], v4, s[28:29]
    global_load_dwordx3 v[76:78], v4, s[28:29] offset:16
    global_load_dwordx4 v[80:83], v4, s[30:31]
    global_load_dwordx3 v[84:86], v4, s[30:31] offset:16
    global_load_dwordx4 v[88:91], v4, s[32:33]
    global_load_dwordx3 v[92:94], v4, s[32:33] offset:16
    s_waitcnt vmcnt(0)
    v_lshlrev_b32 v40, 16, v72
    v_and_b32 v41, 0xffff0000, v72
    v_lshlrev_b32 v42, 16, v73
    v_and_b32 v43, 0xffff0000, v73
    v_lshlrev_b32 v44, 16, v74
    v_and_b32 v45, 0xffff0000, v74
    v_lshlrev_b32 v46, 16, v75
    v_and_b32 v47, 0xffff0000, v75
    v_lshlrev_b32 v48, 16, v76
    v_and_b32 v49, 0xffff0000, v76
    v_lshlrev_b32 v50, 16, v77
    v_and_b32 v51, 0xffff0000, v77
    v_lshlrev_b32 v52, 16, v78
    v_and_b32 v53, 0xffff0000, v78
    v_lshlrev_b32 v54, 16, v80
    v_and_b32 v55, 0xffff0000, v80
    v_lshlrev_b32 v56, 16, v81
    v_and_b32 v57, 0xffff0000, v81
    v_lshlrev_b32 v58, 16, v82
    v_and_b32 v59, 0xffff0000, v82
    v_lshlrev_b32 v60, 16, v83
    v_and_b32 v61, 0xffff0000, v83
    v_lshlrev_b32 v62, 16, v84
    v_and_b32 v63, 0xffff0000, v84
    v_lshlrev_b32 v64, 16, v85
    v_and_b32 v65, 0xffff0000, v85
    v_lshlrev_b32 v66, 16, v86
    v_and_b32 v67, 0xffff0000, v86
    v_lshlrev_b32 v68, 16, v88
    v_and_b32 v69, 0xffff0000, v88
    v_lshlrev_b32 v70, 16, v89
    v_and_b32 v71, 0xffff0000, v89
    v_lshlrev_b32 v72, 16, v90
    v_and_b32 v73, 0xffff0000, v90
    v_lshlrev_b32 v74, 16, v91
    v_and_b32 v75, 0xffff0000, v91
    v_lshlrev_b32 v76, 16, v92
    v_and_b32 v77, 0xffff0000, v92
    v_lshlrev_b32 v78, 16, v93
    v_and_b32 v79, 0xffff0000, v93
    v_lshlrev_b32 v80, 16, v94
    v_and_b32 v81, 0xffff0000, v94
    v_pk_mul_f32 v[82:83], v[54:55], v[68:69]
    v_pk_mul_f32 v[68:69], v[40:41], v[68:69]
    v_pk_mul_f32 v[84:85], v[56:57], v[70:71]
    v_pk_mul_f32 v[70:71], v[42:43], v[70:71]
    v_pk_mul_f32 v[86:87], v[58:59], v[72:73]
    v_pk_mul_f32 v[72:73], v[44:45], v[72:73]
    v_pk_mul_f32 v[88:89], v[60:61], v[74:75]
    v_pk_mul_f32 v[74:75], v[46:47], v[74:75]
    v_pk_mul_f32 v[90:91], v[62:63], v[76:77]
    v_pk_mul_f32 v[76:77], v[48:49], v[76:77]
    v_pk_mul_f32 v[92:93], v[64:65], v[78:79]
    v_pk_mul_f32 v[78:79], v[50:51], v[78:79]
    v_pk_mul_f32 v[94:95], v[66:67], v[80:81]
    v_pk_mul_f32 v[80:81], v[52:53], v[80:81]
    v_pk_fma_f32 v[104:105], v[40:41], s[64:65], v[54:55]
    v_pk_fma_f32 v[106:107], v[42:43], s[64:65], v[56:57]
    v_pk_fma_f32 v[108:109], v[44:45], s[64:65], v[58:59]
    v_pk_fma_f32 v[110:111], v[46:47], s[64:65], v[60:61]
    v_pk_fma_f32 v[112:113], v[48:49], s[64:65], v[62:63]
    v_pk_fma_f32 v[114:115], v[50:51], s[64:65], v[64:65]
    v_pk_fma_f32 v[116:117], v[52:53], s[64:65], v[66:67]
    v_pk_mul_f32 v[118:119], v[104:105], v[104:105]
    v_pk_mul_f32 v[120:121], v[106:107], v[106:107]
    v_pk_mul_f32 v[122:123], v[108:109], v[108:109]
    v_pk_mul_f32 v[124:125], v[110:111], v[110:111]
    v_pk_mul_f32 v[126:127], v[112:113], v[112:113]
    v_pk_mul_f32 v[128:129], v[114:115], v[114:115]
    v_pk_mul_f32 v[130:131], v[116:117], v[116:117]
    v_pk_fma_f32 v[118:119], v[118:119], v[98:99], v[96:97]
    v_pk_fma_f32 v[120:121], v[120:121], v[98:99], v[96:97]
    v_pk_fma_f32 v[122:123], v[122:123], v[98:99], v[96:97]
    v_pk_fma_f32 v[124:125], v[124:125], v[98:99], v[96:97]
    v_pk_fma_f32 v[126:127], v[126:127], v[98:99], v[96:97]
    v_pk_fma_f32 v[128:129], v[128:129], v[98:99], v[96:97]
    v_pk_fma_f32 v[130:131], v[130:131], v[98:99], v[96:97]
    v_pk_mul_f32 v[118:119], v[118:119], v[104:105]
    v_pk_mul_f32 v[120:121], v[120:121], v[106:107]
    v_pk_mul_f32 v[122:123], v[122:123], v[108:109]
    v_pk_mul_f32 v[124:125], v[124:125], v[110:111]
    v_pk_mul_f32 v[126:127], v[126:127], v[112:113]
    v_pk_mul_f32 v[128:129], v[128:129], v[114:115]
    v_pk_mul_f32 v[130:131], v[130:131], v[116:117]
    v_exp_f32 v118, v118
    v_exp_f32 v119, v119
    v_exp_f32 v120, v120
    v_exp_f32 v121, v121
    v_exp_f32 v122, v122
    v_exp_f32 v123, v123
    v_exp_f32 v124, v124
    v_exp_f32 v125, v125
    v_exp_f32 v126, v126
    v_exp_f32 v127, v127
    v_exp_f32 v128, v128
    v_exp_f32 v129, v129
    v_exp_f32 v130, v130
    v_exp_f32 v131, v131
    v_pk_fma_f32 v[104:105], v[68:69], s[64:65], v[82:83]
    v_pk_fma_f32 v[106:107], v[70:71], s[64:65], v[84:85]
    v_pk_fma_f32 v[108:109], v[72:73], s[64:65], v[86:87]
    v_pk_fma_f32 v[110:111], v[74:75], s[64:65], v[88:89]
    v_pk_fma_f32 v[112:113], v[76:77], s[64:65], v[90:91]
    v_pk_fma_f32 v[114:115], v[78:79], s[64:65], v[92:93]
    v_pk_fma_f32 v[116:117], v[80:81], s[64:65], v[94:95]
    v_pk_add_f32 v[118:119], v[118:119], v[100:101]
    v_pk_add_f32 v[120:121], v[120:121], v[100:101]
    v_pk_add_f32 v[122:123], v[122:123], v[100:101]
    v_pk_add_f32 v[124:125], v[124:125], v[100:101]
    v_pk_add_f32 v[126:127], v[126:127], v[100:101]
    v_pk_add_f32 v[128:129], v[128:129], v[100:101]
    v_pk_add_f32 v[130:131], v[130:131], v[100:101]
    v_rcp_f32 v118, v118
    v_rcp_f32 v119, v119
    v_rcp_f32 v120, v120
    v_rcp_f32 v121, v121
    v_rcp_f32 v122, v122
    v_rcp_f32 v123, v123
    v_rcp_f32 v124, v124
    v_rcp_f32 v125, v125
    v_rcp_f32 v126, v126
    v_rcp_f32 v127, v127
    v_rcp_f32 v128, v128
    v_rcp_f32 v129, v129
    v_rcp_f32 v130, v130
    v_rcp_f32 v131, v131
    v_pk_mul_f32 v[102:103], v[104:105], v[118:119]
    v_pk_fma_f32 v[102:103], v[106:107], v[120:121], v[102:103]
    v_pk_fma_f32 v[102:103], v[108:109], v[122:123], v[102:103]
    v_pk_fma_f32 v[102:103], v[110:111], v[124:125], v[102:103]
    v_pk_fma_f32 v[102:103], v[112:113], v[126:127], v[102:103]
    v_pk_fma_f32 v[102:103], v[114:115], v[128:129], v[102:103]
    v_pk_fma_f32 v[102:103], v[116:117], v[130:131], v[102:103]
    v_add_f32 v102, v102, v103
    v_add_f32 v13, v13, v102
    s_add_u32 s6, s6, 1
    s_cmp_lt_u32 s6, 4
    s_cbranch_scc1 L_fb2
    v_add_f32_dpp v13, v13, v13 quad_perm:[1,0,3,2] row_mask:0xf bank_mask:0xf
    s_nop 1
    v_add_f32_dpp v13, v13, v13 quad_perm:[2,3,0,1] row_mask:0xf bank_mask:0xf
    s_nop 1
    v_add_f32_dpp v13, v13, v13 row_half_mirror row_mask:0xf bank_mask:0xf
    s_nop 1
    v_add_f32_dpp v13, v13, v13 row_mirror row_mask:0xf bank_mask:0xf
    v_mov_b32 v14, v13
    s_nop 1
    v_permlane16_swap_b32 v13, v14
    v_add_f32 v13, v13, v14
    v_mov_b32 v14, v13
    s_nop 1
    v_permlane32_swap_b32 v13, v14
    v_add_f32 v13, v13, v14
    v_cmp_eq_u32 vcc, s64, v12
    s_nop 1
    v_cndmask_b32 v15, v15, v13, vcc
    s_andn2_b64 s[66:67], s[66:67], vcc
    s_cbranch_scc1 L_fb
    s_branch L_nofb
L_tab:
    s_cmp_ge_u32 s66, s5
    s_cbranch_scc1 L_tabx
    s_setprio 0
L_tab1:
    s_mov_b32 s65, s64
    v_mov_b32 v5, s63
    ds_read_b32 v5, v5
    s_waitcnt lgkmcnt(0)
    v_readfirstlane_b32 s4, v5
    s_nop 0
    s_cmp_ge_u32 s4, 8
    s_nop 1
    s_cbranch_scc1 L_tabe
    v_pk_fma_f32 v[104:105], v[40:41], s[64:65], v[54:55]
    v_pk_fma_f32 v[106:107], v[42:43], s[64:65], v[56:57]
    v_pk_fma_f32 v[108:109], v[44:45], s[64:65], v[58:59]
    v_pk_fma_f32 v[110:111], v[46:47], s[64:65], v[60:61]
    v_pk_fma_f32 v[112:113], v[48:49], s[64:65], v[62:63]
    v_pk_fma_f32 v[114:115], v[50:51], s[64:65], v[64:65]
    v_pk_fma_f32 v[116:117], v[52:53], s[64:65], v[66:67]
    v_pk_mul_f32 v[118:119], v[104:105], v[104:105]
    v_pk_mul_f32 v[120:121], v[106:107], v[106:107]
    v_pk_mul_f32 v[122:123], v[108:109], v[108:109]
    v_pk_mul_f32 v[124:125], v[110:111], v[110:111]
    v_pk_mul_f32 v[126:127], v[112:113], v[112:113]
    v_pk_mul_f32 v[128:129], v[114:115], v[114:115]
    v_pk_mul_f32 v[130:131], v[116:117], v[116:117]
    v_pk_fma_f32 v[118:119], v[118:119], v[98:99], v[96:97]
    v_pk_fma_f32 v[120:121], v[120:121], v[98:99], v[96:97]
    v_pk_fma_f32 v[122:123], v[122:123], v[98:99], v[96:97]
    v_pk_fma_f32 v[124:125], v[124:125], v[98:99], v[96:97]
    v_pk_fma_f32 v[126:127], v[126:127], v[98:99], v[96:97]
    v_pk_fma_f32 v[128:129], v[128:129], v[98:99], v[96:97]
    v_pk_fma_f32 v[130:131], v[130:131], v[98:99], v[96:97]
    v_pk_mul_f32 v[118:119], v[118:119], v[104:105]
    v_pk_mul_f32 v[120:121], v[120:121], v[106:107]
    v_pk_mul_f32 v[122:123], v[122:123], v[108:109]
    v_pk_mul_f32 v[124:125], v[124:125], v[110:111]
    v_pk_mul_f32 v[126:127], v[126:127], v[112:113]
    v_pk_mul_f32 v[128:129], v[128:129], v[114:115]
    v_pk_mul_f32 v[130:131], v[130:131], v[116:117]
    v_exp_f32 v118, v118
    v_exp_f32 v119, v119
    v_exp_f32 v120, v120
    v_exp_f32 v121, v121
    v_exp_f32 v122, v122
    v_exp_f32 v123, v123
    v_exp_f32 v124, v124
    v_exp_f32 v125, v125
    v_exp_f32 v126, v126
    v_exp_f32 v127, v127
    v_exp_f32 v128, v128
    v_exp_f32 v129, v129
    v_exp_f32 v130, v130
    v_exp_f32 v131, v131
    v_pk_fma_f32 v[104:105], v[68:69], s[64:65], v[82:83]
    v_pk_fma_f32 v[106:107], v[70:71], s[64:65], v[84:85]
    v_pk_fma_f32 v[108:109], v[72:73], s[64:65], v[86:87]
    v_pk_fma_f32 v[110:111], v[74:75], s[64:65], v[88:89]
    v_pk_fma_f32 v[112:113], v[76:77], s[64:65], v[90:91]
    v_pk_fma_f32 v[114:115], v[78:79], s[64:65], v[92:93]
    v_pk_fma_f32 v[116:117], v[80:81], s[64:65], v[94:95]
    v_pk_add_f32 v[118:119], v[118:119], v[100:101]
    v_pk_add_f32 v[120:121], v[120:121], v[100:101]
    v_pk_add_f32 v[122:123], v[122:123], v[100:101]
    v_pk_add_f32 v[124:125], v[124:125], v[100:101]
    v_pk_add_f32 v[126:127], v[126:127], v[100:101]
    v_pk_add_f32 v[128:129], v[128:129], v[100:101]
    v_pk_add_f32 v[130:131], v[130:131], v[100:101]
    v_rcp_f32 v118, v118
    v_rcp_f32 v119, v119
    v_rcp_f32 v120, v120
    v_rcp_f32 v121, v121
    v_rcp_f32 v122, v122
    v_rcp_f32 v123, v123
    v_rcp_f32 v124, v124
    v_rcp_f32 v125, v125
    v_rcp_f32 v126, v126
    v_rcp_f32 v127, v127
    v_rcp_f32 v128, v128
    v_rcp_f32 v129, v129
    v_rcp_f32 v130, v130
    v_rcp_f32 v131, v131
    v_pk_mul_f32 v[102:103], v[104:105], v[118:119]
    v_pk_fma_f32 v[102:103], v[106:107], v[120:121], v[102:103]
    v_pk_fma_f32 v[102:103], v[108:109], v[122:123], v[102:103]
    v_pk_fma_f32 v[102:103], v[110:111], v[124:125], v[102:103]
    v_pk_fma_f32 v[102:103], v[112:113], v[126:127], v[102:103]
    v_pk_fma_f32 v[102:103], v[114:115], v[128:129], v[102:103]
    v_pk_fma_f32 v[102:103], v[116:117], v[130:131], v[102:103]
    v_add_f32 v102, v102, v103
    v_lshrrev_b32 v4, 2, v0
    v_add_u32 v4, s6, v4
    v_add_f32_dpp v102, v102, v102 quad_perm:[1,0,3,2] row_mask:0xf bank_mask:0xf
    s_nop 1
    v_add_f32_dpp v102, v102, v102 quad_perm:[2,3,0,1] row_mask:0xf bank_mask:0xf
    s_nop 1
    v_add_f32_dpp v102, v102, v102 row_half_mirror row_mask:0xf bank_mask:0xf
    s_nop 1
    v_add_f32_dpp v102, v102, v102 row_mirror row_mask:0xf bank_mask:0xf
    s_mov_b32 exec_lo, 0x00010001
    s_mov_b32 exec_hi, 0x00010001
    ds_write_b32 v4, v102 offset:7168
    s_mov_b64 exec, -1
    s_add_u32 s6, s6, 64
    s_add_u32 s64, s64, 0x10000
    s_add_u32 s66, s66, 1
    s_cmp_lt_u32 s66, s5
    s_cbranch_scc1 L_tab1
L_tabe:
    s_setprio 3
L_tabx:
    s_setpc_b64 s[68:69]
L_codeend:
.section .rodata,"a"
.p2align 6
.amdhsa_kernel adaLN_cond__gqa_block_cached__mixer_token_mlp__decode_kernel
  .amdhsa_next_free_vgpr 168
  .amdhsa_next_free_sgpr 102
  .amdhsa_accum_offset 168
  .amdhsa_group_segment_fixed_size 0
  .amdhsa_kernarg_size 120
  .amdhsa_user_sgpr_count 2
  .amdhsa_user_sgpr_kernarg_segment_ptr 1
  .amdhsa_system_sgpr_workgroup_id_x 1
.end_amdhsa_kernel
```
